```python
import torch

def _softmax(x, axis=-1):
    return torch.softmax(x, dim=axis)
def _gelu(x):
    return torch.nn.functional.gelu(x, approximate="tanh")
def _silu(x):
    return torch.nn.functional.silu(x)
def _sigmoid(x):
    return torch.sigmoid(x)
def _layernorm(x, axis=-1, eps=1e-5):
    m = x.mean(dim=axis, keepdim=True)
    v = x.var(dim=axis, keepdim=True, unbiased=False)
    return (x - m) / torch.sqrt(v + eps)
def _scatter_add(tgt, idx, src, axis=0):
    return tgt.clone().index_add_(axis, idx, src)
def _segment_sum(src, seg, n):
    out = torch.zeros((n,) + src.shape[1:], dtype=src.dtype)
    return out.index_add_(0, seg, src)
def _pad(x, pw):
    flat = tuple(v for pair in reversed(pw) for v in pair)
    return torch.nn.functional.pad(x, flat)

kernel_name = 'sequential_preLN__sliding_block_cached__dense_activation_squared_relu__decode'

def setup_inputs():

    _w = (lambda a: (lambda t: t.to(torch.bfloat16) if t.is_floating_point() else t)(torch.as_tensor(a)))
    def _A_setup():
        B, Sq, D = 1, 1, 512
        Hq, Hkv, Sk, Dh = 32, 32, 4096, 128
        assert Hq % Hkv == 0, (Hq, Hkv)
        return {
            "x": _w((lambda *s: torch.randn(*s, dtype=torch.bfloat16) * 0.05)(B, Sq, D)),
            "k_cache": _w((lambda *s: torch.randn(*s, dtype=torch.bfloat16) * 3.2)(B, Hkv, Sk, Dh)),
            "v_cache": _w((lambda *s: torch.randn(*s, dtype=torch.bfloat16) * 0.4)(B, Hkv, Sk, Dh)),
            "wq": _w((lambda *s: torch.randn(*s, dtype=torch.bfloat16) * 3.2)(D, Hq * Dh) * (D ** -0.5)),
            "wo": _w((lambda *s: torch.randn(*s, dtype=torch.bfloat16) * 0.4)(Hq * Dh, D) * ((Hq * Dh) ** -0.5)),
        }
    _A_in = _A_setup()

    def _B_setup():
        B, S, D, F = 1, 1, 512, 1376
        return {
            "x": _w((lambda *s: torch.randn(*s, dtype=torch.bfloat16) * 0.05)(B, S, D)),
            "w1": _w((lambda *s: torch.randn(*s, dtype=torch.bfloat16) * 0.05)(D, F)),
            "b1": _w((lambda *s: torch.randn(*s, dtype=torch.bfloat16) * 0.4)(F)),
            "w2": _w((lambda *s: torch.randn(*s, dtype=torch.bfloat16) * 0.05)(F, D)),
            "b2": _w((lambda *s: torch.randn(*s, dtype=torch.bfloat16) * 1.6)(D)),
        }
    _B_in = _B_setup()

    return {
        "A_x": _A_in["x"],
        "A_k_cache": _A_in["k_cache"],
        "A_v_cache": _A_in["v_cache"],
        "A_wq": _A_in["wq"],
        "A_wo": _A_in["wo"],
        "B_x": _B_in["x"],
        "B_w1": _B_in["w1"],
        "B_b1": _B_in["b1"],
        "B_w2": _B_in["w2"],
        "B_b2": _B_in["b2"],
    }

def reference(A_x, A_k_cache, A_v_cache, A_wq, A_wo, B_x, B_w1, B_b1, B_w2, B_b2):
    def _A_ref(x, k_cache, v_cache, wq, wo):
        B, Sq, D = x.shape
        Hq, Dh = 32, 128
        Hkv, Sk = k_cache.shape[1], k_cache.shape[2]
        W = min(4096, max(256, Sk // 4))
        rep = Hq // Hkv
        q = (lambda x, *d: x.permute(*d))((x @ wq).reshape(B, Sq, Hq, Dh), 0, 2, 1, 3)
        k = (lambda x, n, axis: torch.repeat_interleave(x, n, dim=axis))(k_cache[:, :, Sk - W:, :], rep, axis=1)
        v = (lambda x, n, axis: torch.repeat_interleave(x, n, dim=axis))(v_cache[:, :, Sk - W:, :], rep, axis=1)
        scores = torch.einsum("bhqd,bhkd->bhqk", q, k) * (Dh ** -0.5)
        p = _softmax(scores, axis=-1)
        o = torch.einsum("bhqk,bhkd->bhqd", p, v)
        return (lambda x, *d: x.permute(*d))(o, 0, 2, 1, 3).reshape(B, Sq, Hq * Dh) @ wo

    def _B_ref(x, w1, b1, w2, b2):
        h = torch.einsum("bsd,df->bsf", x, w1) + b1
        zero = torch.zeros_like(h)
        r = torch.where(h > zero, h, zero)
        h = r * r
        out = torch.einsum("bsf,fd->bsd", h, w2) + b2
        return out

    x = A_x
    h = x + _A_ref(_layernorm(x, axis=-1), A_k_cache, A_v_cache, A_wq, A_wo)
    h2 = h + _B_ref(_layernorm(h, axis=-1), B_w1, B_b1, B_w2, B_b2)
    return h2
```

```asm
; @launch grid=(256,1,1) block=(320,1,1) lds=8704
.amdgcn_target "amdgcn-amd-amdhsa--gfx950"
.text
.globl sequential_preLN__sliding_block_cached__dense_activation_squared_relu__decode_kernel
.p2align 8
.type sequential_preLN__sliding_block_cached__dense_activation_squared_relu__decode_kernel,@function
sequential_preLN__sliding_block_cached__dense_activation_squared_relu__decode_kernel:
    s_cmp_ge_u32 s2, 256
    s_cbranch_scc1 L_end
    s_load_dwordx16 s[4:19], s[0:1], 0
    s_load_dwordx8 s[20:27], s[0:1], 64
    s_load_dwordx2 s[28:29], s[0:1], 96
    v_lshrrev_b32 v1, 6, v0
    v_lshlrev_b32 v8, 6, v0
    v_readfirstlane_b32 s3, v1
    s_getpc_b64 s[56:57]
L_pc:
    v_min_u32 v8, L_codeend-L_pc-4+4096, v8
    s_cmp_lt_u32 s2, 8
    s_cselect_b32 s35, s3, 0
    s_cmp_eq_u32 s35, 0
    s_cbranch_scc1 L_nocpf
    global_load_dword v188, v8, s[56:57] offset:-4096
L_nocpf:
    v_and_b32 v0, 63, v0
    v_lshrrev_b32 v1, 4, v0
    v_and_b32 v2, 15, v0
    s_and_b32 s32, s2, 7
    s_lshr_b32 s33, s2, 3
    s_and_b32 s30, s33, 3
    s_lshl_b32 s35, s32, 2
    s_add_u32 s30, s30, s35
    s_lshr_b32 s31, s33, 2
    s_mov_b32 s40, 0x0f0f0f0f
    s_mov_b32 s41, 0x0f0f0f0f
    s_mov_b32 s42, 0xffff0000
    s_mov_b32 s43, 0x3fb8aa3b
    s_movk_i32 s61, 0xff
    s_cmp_lg_u32 s3, 0
    s_cbranch_scc1 L_comp
    s_setprio 3
    v_lshlrev_b32 v10, 4, v0
    s_lshl_b32 s35, s31, 7
    v_lshl_add_u32 v11, v0, 1, s35
    v_mov_b32 v24, 0
    v_lshlrev_b32 v25, 17, v1
    v_lshl_add_u32 v25, v2, 4, v25
    s_lshl_b32 s35, s31, 19
    s_lshl_b32 s37, s30, 8
    s_add_u32 s35, s35, s37
    s_waitcnt lgkmcnt(0)
    s_load_dword s34, s[28:29], 0
    global_load_dwordx4 v[12:15], v10, s[4:5]
    global_load_short_d16_hi v24, v11, s[4:5]
    s_add_u32 s10, s10, s35
    s_addc_u32 s11, s11, 0
    global_load_dwordx4 v[32:35], v25, s[10:11]
    v_add_u32 v25, 0x2000, v25
    global_load_dwordx4 v[36:39], v25, s[10:11]
    v_add_u32 v25, 0x2000, v25
    global_load_dwordx4 v[40:43], v25, s[10:11]
    v_add_u32 v25, 0x2000, v25
    global_load_dwordx4 v[44:47], v25, s[10:11]
    v_add_u32 v25, 0x2000, v25
    global_load_dwordx4 v[48:51], v25, s[10:11]
    v_add_u32 v25, 0x2000, v25
    global_load_dwordx4 v[52:55], v25, s[10:11]
    v_add_u32 v25, 0x2000, v25
    global_load_dwordx4 v[56:59], v25, s[10:11]
    v_add_u32 v25, 0x2000, v25
    global_load_dwordx4 v[60:63], v25, s[10:11]
    v_add_u32 v25, 0x2000, v25
    global_load_dwordx4 v[64:67], v25, s[10:11]
    v_add_u32 v25, 0x2000, v25
    global_load_dwordx4 v[68:71], v25, s[10:11]
    v_add_u32 v25, 0x2000, v25
    global_load_dwordx4 v[72:75], v25, s[10:11]
    v_add_u32 v25, 0x2000, v25
    global_load_dwordx4 v[76:79], v25, s[10:11]
    v_add_u32 v25, 0x2000, v25
    global_load_dwordx4 v[80:83], v25, s[10:11]
    v_add_u32 v25, 0x2000, v25
    global_load_dwordx4 v[84:87], v25, s[10:11]
    v_add_u32 v25, 0x2000, v25
    global_load_dwordx4 v[88:91], v25, s[10:11]
    v_add_u32 v25, 0x2000, v25
    global_load_dwordx4 v[92:95], v25, s[10:11]
    s_branch L_w0
L_comp:
    s_sub_u32 s38, s3, 1
    v_lshrrev_b32 v8, 2, v2
    v_lshlrev_b32 v8, 8, v8
    v_lshl_add_u32 v8, v1, 6, v8
    v_and_b32 v9, 3, v0
    v_lshl_add_u32 v11, v9, 4, v8
    v_lshlrev_b32 v10, 4, v0
    s_lshl_b32 s35, s30, 20
    s_lshl_b32 s37, s31, 15
    s_add_u32 s35, s35, s37
    s_lshl_b32 s37, s38, 13
    s_add_u32 s35, s35, s37
    s_add_u32 s35, s35, 790528
    s_waitcnt lgkmcnt(0)
    s_load_dword s34, s[28:29], 0
    s_add_u32 s6, s6, s35
    s_addc_u32 s7, s7, 0
    s_add_u32 s8, s8, s35
    s_addc_u32 s9, s9, 0
    v_and_b32 v8, 1, v0
    v_lshlrev_b32 v8, 4, v8
    v_mov_b32 v9, 0xffff
    v_lshlrev_b32 v9, v8, v9
    v_and_b32 v3, 3, v0
    v_lshrrev_b32 v8, 1, v0
    v_and_or_b32 v3, v8, 4, v3
    v_lshrrev_b32 v8, 1, v3
    v_cmp_eq_u32 vcc, 0, v8
    s_nop 1
    v_cndmask_b32 v4, 0, v9, vcc
    v_cmp_eq_u32 vcc, 1, v8
    s_nop 1
    v_cndmask_b32 v5, 0, v9, vcc
    v_cmp_eq_u32 vcc, 2, v8
    s_nop 1
    v_cndmask_b32 v6, 0, v9, vcc
    v_cmp_eq_u32 vcc, 3, v8
    s_nop 1
    v_cndmask_b32 v7, 0, v9, vcc
    v_mov_b32 v160, 0
    v_mov_b32 v161, 0
    v_mov_b32 v162, 0
    v_mov_b32 v163, 0
    v_mov_b32 v164, 0
    v_mov_b32 v165, 0
    v_mov_b32 v166, 0
    v_mov_b32 v167, 0
    v_mov_b32 v168, 0
    v_mov_b32 v169, 0
    v_mov_b32 v170, 0
    v_mov_b32 v171, 0
    v_mov_b32 v172, 0
    v_mov_b32 v173, 0
    v_mov_b32 v174, 0
    v_mov_b32 v175, 0
    v_lshlrev_b32 v12, 6, v1
    v_and_b32 v9, 3, v0
    v_lshl_add_u32 v12, v9, 4, v12
    s_lshl_b32 s35, s38, 3
    v_mov_b32 v13, s35
    v_lshl_add_u32 v14, v1, 3, v3
    s_lshl_b32 s35, s38, 9
    v_lshl_add_u32 v14, v14, 4, s35
    s_mov_b32 s62, 0x55555555
    s_mov_b32 s63, 0x55555555
    s_mov_b32 s46, 0x000f000f
    s_mov_b32 s47, 0x000f000f
    s_lshl_b64 s[48:49], s[46:47], 4
    s_lshl_b64 s[50:51], s[46:47], 8
    s_lshl_b64 s[52:53], s[46:47], 12
    s_barrier
    global_load_dwordx4 v[32:35], v11, s[6:7] offset:-4096 nt
    global_load_dwordx4 v[36:39], v11, s[6:7] offset:-3072 nt
    global_load_dwordx4 v[40:43], v11, s[6:7] offset:-2048 nt
    global_load_dwordx4 v[44:47], v11, s[6:7] offset:-1024 nt
    s_waitcnt vmcnt(3)
    global_load_dwordx4 v[48:51], v11, s[6:7] offset:0 nt
    s_waitcnt vmcnt(3)
    global_load_dwordx4 v[52:55], v11, s[6:7] offset:1024 nt
    s_waitcnt vmcnt(3)
    global_load_dwordx4 v[56:59], v11, s[6:7] offset:2048 nt
    s_waitcnt vmcnt(3)
    global_load_dwordx4 v[60:63], v11, s[6:7] offset:3072 nt
    s_waitcnt vmcnt(3)
    global_load_dwordx4 v[64:67], v10, s[8:9] offset:-4096 nt
    s_waitcnt vmcnt(3)
    global_load_dwordx4 v[68:71], v10, s[8:9] offset:-3072 nt
    s_waitcnt vmcnt(3)
    global_load_dwordx4 v[72:75], v10, s[8:9] offset:-2048 nt
    s_waitcnt vmcnt(3)
    global_load_dwordx4 v[76:79], v10, s[8:9] offset:-1024 nt
    s_cmp_lt_u32 s33, 16
    s_cbranch_scc1 L_att_wo
    s_sub_u32 s39, s2, 128
    s_cmp_lt_u32 s39, 43
    s_cbranch_scc1 L_att_ffn
    s_branch L_comp2
L_w0:
    s_lshl_b32 s35, s30, 12
    s_lshl_b32 s37, s31, 9
    s_add_u32 s35, s35, s37
    s_add_u32 s35, s35, 65536
    v_and_b32 v30, 3, v0
    v_lshl_add_u32 v30, v30, 7, s35
    v_lshrrev_b32 v31, 2, v0
    v_lshl_add_u32 v30, v31, 17, v30
    s_lshl_b32 s35, s30, 7
    s_add_u32 s35, s35, 327680
    v_writelane_b32 v30, s35, 8
    s_mov_b64 exec, 0x1ff
    global_load_dword v168, v30, s[28:29] sc1
    s_mov_b64 exec, -1
    v_and_b32 v8, 1, v0
    v_lshlrev_b32 v8, 4, v8
    v_mov_b32 v9, 0xffff
    v_lshlrev_b32 v9, v8, v9
    v_and_b32 v3, 3, v0
    v_lshrrev_b32 v8, 1, v0
    v_and_or_b32 v3, v8, 4, v3
    v_lshrrev_b32 v8, 1, v3
    v_cmp_eq_u32 vcc, 0, v8
    s_nop 1
    v_cndmask_b32 v4, 0, v9, vcc
    v_cmp_eq_u32 vcc, 1, v8
    s_nop 1
    v_cndmask_b32 v5, 0, v9, vcc
    v_cmp_eq_u32 vcc, 2, v8
    s_nop 1
    v_cndmask_b32 v6, 0, v9, vcc
    v_cmp_eq_u32 vcc, 3, v8
    s_nop 1
    v_cndmask_b32 v7, 0, v9, vcc
    s_lshl_b32 s35, s30, 12
    s_add_u32 s35, s35, 65536
    s_add_u32 s44, s28, s35
    s_addc_u32 s45, s29, 0
    s_lshl_b32 s35, s31, 9
    v_lshl_add_u32 v26, v1, 3, v3
    v_lshl_add_u32 v27, v26, 4, s35
    s_waitcnt vmcnt(17)
    v_lshlrev_b32 v16, 16, v12
    v_and_b32 v17, s42, v12
    v_lshlrev_b32 v18, 16, v13
    v_and_b32 v19, s42, v13
    v_lshlrev_b32 v20, 16, v14
    v_and_b32 v21, s42, v14
    v_lshlrev_b32 v22, 16, v15
    v_and_b32 v23, s42, v15
    v_pk_add_f32 v[8:9], v[16:17], v[18:19]
    v_pk_add_f32 v[12:13], v[20:21], v[22:23]
    v_pk_add_f32 v[8:9], v[8:9], v[12:13]
    v_add_f32 v8, v8, v9
    s_nop 1
    v_add_f32 v8, v8, v8 row_ror:8 row_mask:0xf bank_mask:0xf
    s_nop 1
    v_add_f32 v8, v8, v8 row_ror:4 row_mask:0xf bank_mask:0xf
    s_nop 1
    v_add_f32 v8, v8, v8 row_ror:2 row_mask:0xf bank_mask:0xf
    s_nop 1
    v_add_f32 v8, v8, v8 row_ror:1 row_mask:0xf bank_mask:0xf
    v_mov_b32 v9, v8
    s_nop 1
    v_permlane16_swap_b32 v8, v9
    v_add_f32 v8, v8, v9
    v_mov_b32 v9, v8
    s_nop 1
    v_permlane32_swap_b32 v8, v9
    v_add_f32 v8, v8, v9
    v_mul_f32 v8, 0x3b000000, v8
    v_pk_add_f32 v[16:17], v[16:17], v[8:9] op_sel_hi:[1,0] neg_lo:[0,1] neg_hi:[0,1]
    v_pk_add_f32 v[18:19], v[18:19], v[8:9] op_sel_hi:[1,0] neg_lo:[0,1] neg_hi:[0,1]
    v_pk_add_f32 v[20:21], v[20:21], v[8:9] op_sel_hi:[1,0] neg_lo:[0,1] neg_hi:[0,1]
    v_pk_add_f32 v[22:23], v[22:23], v[8:9] op_sel_hi:[1,0] neg_lo:[0,1] neg_hi:[0,1]
    v_pk_mul_f32 v[12:13], v[16:17], v[16:17]
    v_pk_fma_f32 v[12:13], v[18:19], v[18:19], v[12:13]
    v_pk_fma_f32 v[12:13], v[20:21], v[20:21], v[12:13]
    v_pk_fma_f32 v[12:13], v[22:23], v[22:23], v[12:13]
    v_add_f32 v12, v12, v13
    s_nop 1
    v_add_f32 v12, v12, v12 row_ror:8 row_mask:0xf bank_mask:0xf
    s_nop 1
    v_add_f32 v12, v12, v12 row_ror:4 row_mask:0xf bank_mask:0xf
    s_nop 1
    v_add_f32 v12, v12, v12 row_ror:2 row_mask:0xf bank_mask:0xf
    s_nop 1
    v_add_f32 v12, v12, v12 row_ror:1 row_mask:0xf bank_mask:0xf
    v_mov_b32 v13, v12
    s_nop 1
    v_permlane16_swap_b32 v12, v13
    v_add_f32 v12, v12, v13
    v_mov_b32 v13, v12
    s_nop 1
    v_permlane32_swap_b32 v12, v13
    v_add_f32 v12, v12, v13
    v_mul_f32 v12, 0x3b000000, v12
    v_cvt_pk_bf16_f32 v8, v8, v12
    v_and_b32 v12, s42, v8
    v_lshlrev_b32 v8, 16, v8
    v_add_f32 v12, 0x3727c5ac, v12
    v_sub_f32 v24, v24, v8
    v_cvt_pk_bf16_f32 v12, v12, v24
    v_and_b32 v24, s42, v12
    v_lshlrev_b32 v12, 16, v12
    v_sqrt_f32 v12, v12
    s_nop 0
    v_cvt_pk_bf16_f32 v12, v12, v12
    v_lshlrev_b32 v12, 16, v12
    v_rcp_f32 v12, v12
    s_nop 0
    v_mul_f32 v24, v24, v12
    v_cvt_pk_bf16_f32 v24, v24, v24
    s_barrier
    s_nop 0
    v_and_b32 v96, v24, v4 row_newbcast:0 row_mask:0xf bank_mask:0xf
    v_and_b32 v97, v24, v5 row_newbcast:0 row_mask:0xf bank_mask:0xf
    v_and_b32 v98, v24, v6 row_newbcast:0 row_mask:0xf bank_mask:0xf
    v_and_b32 v99, v24, v7 row_newbcast:0 row_mask:0xf bank_mask:0xf
    v_and_b32 v100, v24, v4 row_newbcast:1 row_mask:0xf bank_mask:0xf
    v_and_b32 v101, v24, v5 row_newbcast:1 row_mask:0xf bank_mask:0xf
    v_and_b32 v102, v24, v6 row_newbcast:1 row_mask:0xf bank_mask:0xf
    v_and_b32 v103, v24, v7 row_newbcast:1 row_mask:0xf bank_mask:0xf
    s_waitcnt vmcnt(16)
    v_mfma_f32_16x16x32_bf16 v[160:163], v[32:35], v[96:99], 0
    v_and_b32 v104, v24, v4 row_newbcast:2 row_mask:0xf bank_mask:0xf
    v_and_b32 v105, v24, v5 row_newbcast:2 row_mask:0xf bank_mask:0xf
    v_and_b32 v106, v24, v6 row_newbcast:2 row_mask:0xf bank_mask:0xf
    v_and_b32 v107, v24, v7 row_newbcast:2 row_mask:0xf bank_mask:0xf
    s_waitcnt vmcnt(15)
    v_mfma_f32_16x16x32_bf16 v[160:163], v[36:39], v[100:103], v[160:163]
    v_and_b32 v108, v24, v4 row_newbcast:3 row_mask:0xf bank_mask:0xf
    v_and_b32 v109, v24, v5 row_newbcast:3 row_mask:0xf bank_mask:0xf
    v_and_b32 v110, v24, v6 row_newbcast:3 row_mask:0xf bank_mask:0xf
    v_and_b32 v111, v24, v7 row_newbcast:3 row_mask:0xf bank_mask:0xf
    s_waitcnt vmcnt(14)
    v_mfma_f32_16x16x32_bf16 v[160:163], v[40:43], v[104:107], v[160:163]
    v_and_b32 v112, v24, v4 row_newbcast:4 row_mask:0xf bank_mask:0xf
    v_and_b32 v113, v24, v5 row_newbcast:4 row_mask:0xf bank_mask:0xf
    v_and_b32 v114, v24, v6 row_newbcast:4 row_mask:0xf bank_mask:0xf
    v_and_b32 v115, v24, v7 row_newbcast:4 row_mask:0xf bank_mask:0xf
    s_waitcnt vmcnt(13)
    v_mfma_f32_16x16x32_bf16 v[160:163], v[44:47], v[108:111], v[160:163]
    v_and_b32 v116, v24, v4 row_newbcast:5 row_mask:0xf bank_mask:0xf
    v_and_b32 v117, v24, v5 row_newbcast:5 row_mask:0xf bank_mask:0xf
    v_and_b32 v118, v24, v6 row_newbcast:5 row_mask:0xf bank_mask:0xf
    v_and_b32 v119, v24, v7 row_newbcast:5 row_mask:0xf bank_mask:0xf
    s_waitcnt vmcnt(12)
    v_mfma_f32_16x16x32_bf16 v[160:163], v[48:51], v[112:115], v[160:163]
    v_and_b32 v120, v24, v4 row_newbcast:6 row_mask:0xf bank_mask:0xf
    v_and_b32 v121, v24, v5 row_newbcast:6 row_mask:0xf bank_mask:0xf
    v_and_b32 v122, v24, v6 row_newbcast:6 row_mask:0xf bank_mask:0xf
    v_and_b32 v123, v24, v7 row_newbcast:6 row_mask:0xf bank_mask:0xf
    s_waitcnt vmcnt(11)
    v_mfma_f32_16x16x32_bf16 v[160:163], v[52:55], v[116:119], v[160:163]
    v_and_b32 v124, v24, v4 row_newbcast:7 row_mask:0xf bank_mask:0xf
    v_and_b32 v125, v24, v5 row_newbcast:7 row_mask:0xf bank_mask:0xf
    v_and_b32 v126, v24, v6 row_newbcast:7 row_mask:0xf bank_mask:0xf
    v_and_b32 v127, v24, v7 row_newbcast:7 row_mask:0xf bank_mask:0xf
    s_waitcnt vmcnt(10)
    v_mfma_f32_16x16x32_bf16 v[160:163], v[56:59], v[120:123], v[160:163]
    v_and_b32 v128, v24, v4 row_newbcast:8 row_mask:0xf bank_mask:0xf
    v_and_b32 v129, v24, v5 row_newbcast:8 row_mask:0xf bank_mask:0xf
    v_and_b32 v130, v24, v6 row_newbcast:8 row_mask:0xf bank_mask:0xf
    v_and_b32 v131, v24, v7 row_newbcast:8 row_mask:0xf bank_mask:0xf
    s_waitcnt vmcnt(9)
    v_mfma_f32_16x16x32_bf16 v[160:163], v[60:63], v[124:127], v[160:163]
    v_and_b32 v132, v24, v4 row_newbcast:9 row_mask:0xf bank_mask:0xf
    v_and_b32 v133, v24, v5 row_newbcast:9 row_mask:0xf bank_mask:0xf
    v_and_b32 v134, v24, v6 row_newbcast:9 row_mask:0xf bank_mask:0xf
    v_and_b32 v135, v24, v7 row_newbcast:9 row_mask:0xf bank_mask:0xf
    s_waitcnt vmcnt(8)
    v_mfma_f32_16x16x32_bf16 v[160:163], v[64:67], v[128:131], v[160:163]
    v_and_b32 v136, v24, v4 row_newbcast:10 row_mask:0xf bank_mask:0xf
    v_and_b32 v137, v24, v5 row_newbcast:10 row_mask:0xf bank_mask:0xf
    v_and_b32 v138, v24, v6 row_newbcast:10 row_mask:0xf bank_mask:0xf
    v_and_b32 v139, v24, v7 row_newbcast:10 row_mask:0xf bank_mask:0xf
    s_waitcnt vmcnt(7)
    v_mfma_f32_16x16x32_bf16 v[160:163], v[68:71], v[132:135], v[160:163]
    v_and_b32 v140, v24, v4 row_newbcast:11 row_mask:0xf bank_mask:0xf
    v_and_b32 v141, v24, v5 row_newbcast:11 row_mask:0xf bank_mask:0xf
    v_and_b32 v142, v24, v6 row_newbcast:11 row_mask:0xf bank_mask:0xf
    v_and_b32 v143, v24, v7 row_newbcast:11 row_mask:0xf bank_mask:0xf
    s_waitcnt vmcnt(6)
    v_mfma_f32_16x16x32_bf16 v[160:163], v[72:75], v[136:139], v[160:163]
    v_and_b32 v144, v24, v4 row_newbcast:12 row_mask:0xf bank_mask:0xf
    v_and_b32 v145, v24, v5 row_newbcast:12 row_mask:0xf bank_mask:0xf
    v_and_b32 v146, v24, v6 row_newbcast:12 row_mask:0xf bank_mask:0xf
    v_and_b32 v147, v24, v7 row_newbcast:12 row_mask:0xf bank_mask:0xf
    s_waitcnt vmcnt(5)
    v_mfma_f32_16x16x32_bf16 v[160:163], v[76:79], v[140:143], v[160:163]
    v_and_b32 v148, v24, v4 row_newbcast:13 row_mask:0xf bank_mask:0xf
    v_and_b32 v149, v24, v5 row_newbcast:13 row_mask:0xf bank_mask:0xf
    v_and_b32 v150, v24, v6 row_newbcast:13 row_mask:0xf bank_mask:0xf
    v_and_b32 v151, v24, v7 row_newbcast:13 row_mask:0xf bank_mask:0xf
    s_waitcnt vmcnt(4)
    v_mfma_f32_16x16x32_bf16 v[160:163], v[80:83], v[144:147], v[160:163]
    v_and_b32 v152, v24, v4 row_newbcast:14 row_mask:0xf bank_mask:0xf
    v_and_b32 v153, v24, v5 row_newbcast:14 row_mask:0xf bank_mask:0xf
    v_and_b32 v154, v24, v6 row_newbcast:14 row_mask:0xf bank_mask:0xf
    v_and_b32 v155, v24, v7 row_newbcast:14 row_mask:0xf bank_mask:0xf
    s_waitcnt vmcnt(3)
    v_mfma_f32_16x16x32_bf16 v[160:163], v[84:87], v[148:151], v[160:163]
    v_and_b32 v156, v24, v4 row_newbcast:15 row_mask:0xf bank_mask:0xf
    v_and_b32 v157, v24, v5 row_newbcast:15 row_mask:0xf bank_mask:0xf
    v_and_b32 v158, v24, v6 row_newbcast:15 row_mask:0xf bank_mask:0xf
    v_and_b32 v159, v24, v7 row_newbcast:15 row_mask:0xf bank_mask:0xf
    s_waitcnt vmcnt(2)
    v_mfma_f32_16x16x32_bf16 v[160:163], v[88:91], v[152:155], v[160:163]
    s_waitcnt vmcnt(1) lgkmcnt(0)
    v_mfma_f32_16x16x32_bf16 v[160:163], v[92:95], v[156:159], v[160:163]
    s_add_u32 s34, s34, 1
    v_add_u32 v26, s34, v26
    v_and_b32 v28, 31, v0
    v_add_u32 v28, s34, v28
    v_and_b32 v28, s61, v28
    s_mov_b64 exec, s[40:41]
    s_nop 1
    v_add_u32 v160, 0x80, v160
    v_add_u32 v161, 0x80, v161
    v_add_u32 v162, 0x80, v162
    v_add_u32 v163, 0x80, v163
    v_bfi_b32 v160, s61, v26, v160
    v_bfi_b32 v161, s61, v26, v161
    v_bfi_b32 v162, s61, v26, v162
    v_bfi_b32 v163, s61, v26, v163
    global_store_dwordx4 v27, v[160:163], s[44:45]
    s_mov_b64 exec, -1
    global_load_dwordx4 v[32:35], v10, s[44:45] offset:0 sc1
    global_load_dwordx4 v[36:39], v10, s[44:45] offset:1024 sc1
    global_load_dwordx4 v[40:43], v10, s[44:45] offset:2048 sc1
    global_load_dwordx4 v[44:47], v10, s[44:45] offset:3072 sc1
    v_bfe_u32 v8, v0, 3, 2
    v_lshlrev_b32 v8, 6, v8
    v_lshrrev_b32 v9, 5, v0
    v_lshl_add_u32 v8, v9, 5, v8
    v_and_b32 v9, 7, v0
    v_lshl_add_u32 v29, v9, 1, v8
    v_add_u32 v31, 524288, v27
    s_mov_b32 s36, 200000
    s_sleep 8
    global_load_dwordx4 v[48:51], v10, s[44:45] offset:0 sc1
    global_load_dwordx4 v[52:55], v10, s[44:45] offset:1024 sc1
    global_load_dwordx4 v[56:59], v10, s[44:45] offset:2048 sc1
    global_load_dwordx4 v[60:63], v10, s[44:45] offset:3072 sc1
    s_sleep 8
    global_load_dwordx4 v[64:67], v10, s[44:45] offset:0 sc1
    global_load_dwordx4 v[68:71], v10, s[44:45] offset:1024 sc1
    global_load_dwordx4 v[72:75], v10, s[44:45] offset:2048 sc1
    global_load_dwordx4 v[76:79], v10, s[44:45] offset:3072 sc1
    s_sleep 8
    global_load_dwordx4 v[80:83], v10, s[44:45] offset:0 sc1
    global_load_dwordx4 v[84:87], v10, s[44:45] offset:1024 sc1
    global_load_dwordx4 v[88:91], v10, s[44:45] offset:2048 sc1
    global_load_dwordx4 v[92:95], v10, s[44:45] offset:3072 sc1
L_qp:
    s_waitcnt vmcnt(12)
    v_xor_b32 v32, v32, v28
    v_xor_b32 v33, v33, v28
    v_xor_b32 v34, v34, v28
    v_xor_b32 v35, v35, v28
    v_xor_b32 v36, v36, v28
    v_xor_b32 v37, v37, v28
    v_xor_b32 v38, v38, v28
    v_xor_b32 v39, v39, v28
    v_xor_b32 v40, v40, v28
    v_xor_b32 v41, v41, v28
    v_xor_b32 v42, v42, v28
    v_xor_b32 v43, v43, v28
    v_xor_b32 v44, v44, v28
    v_xor_b32 v45, v45, v28
    v_xor_b32 v46, v46, v28
    v_xor_b32 v47, v47, v28
    v_or3_b32 v8, v32, v33, v34
    v_or3_b32 v8, v8, v35, v36
    v_or3_b32 v8, v8, v37, v38
    v_or3_b32 v8, v8, v39, v40
    v_or3_b32 v8, v8, v41, v42
    v_or3_b32 v8, v8, v43, v44
    v_or3_b32 v8, v8, v45, v46
    v_or_b32 v8, v8, v47
    v_and_b32 v8, s61, v8
    v_cmp_ne_u32 vcc, 0, v8
    s_cbranch_vccz L_qok0
    s_sub_u32 s36, s36, 1
    s_cbranch_scc1 L_qok0
    s_and_b32 s35, s36, 7
    s_cselect_b32 s35, 0, 524288
    v_add_u32 v30, s35, v10
    s_cbranch_scc0 L_qs
L_qs_d:
    global_load_dwordx4 v[32:35], v30, s[44:45] offset:0 sc1
    global_load_dwordx4 v[36:39], v30, s[44:45] offset:1024 sc1
    global_load_dwordx4 v[40:43], v30, s[44:45] offset:2048 sc1
    global_load_dwordx4 v[44:47], v30, s[44:45] offset:3072 sc1
    s_waitcnt vmcnt(12)
    v_xor_b32 v48, v48, v28
    v_xor_b32 v49, v49, v28
    v_xor_b32 v50, v50, v28
    v_xor_b32 v51, v51, v28
    v_xor_b32 v52, v52, v28
    v_xor_b32 v53, v53, v28
    v_xor_b32 v54, v54, v28
    v_xor_b32 v55, v55, v28
    v_xor_b32 v56, v56, v28
    v_xor_b32 v57, v57, v28
    v_xor_b32 v58, v58, v28
    v_xor_b32 v59, v59, v28
    v_xor_b32 v60, v60, v28
    v_xor_b32 v61, v61, v28
    v_xor_b32 v62, v62, v28
    v_xor_b32 v63, v63, v28
    v_or3_b32 v8, v48, v49, v50
    v_or3_b32 v8, v8, v51, v52
    v_or3_b32 v8, v8, v53, v54
    v_or3_b32 v8, v8, v55, v56
    v_or3_b32 v8, v8, v57, v58
    v_or3_b32 v8, v8, v59, v60
    v_or3_b32 v8, v8, v61, v62
    v_or_b32 v8, v8, v63
    v_and_b32 v8, s61, v8
    v_cmp_ne_u32 vcc, 0, v8
    s_cbranch_vccz L_qok1
    global_load_dwordx4 v[48:51], v10, s[44:45] offset:0 sc1
    global_load_dwordx4 v[52:55], v10, s[44:45] offset:1024 sc1
    global_load_dwordx4 v[56:59], v10, s[44:45] offset:2048 sc1
    global_load_dwordx4 v[60:63], v10, s[44:45] offset:3072 sc1
    s_waitcnt vmcnt(12)
    v_xor_b32 v64, v64, v28
    v_xor_b32 v65, v65, v28
    v_xor_b32 v66, v66, v28
    v_xor_b32 v67, v67, v28
    v_xor_b32 v68, v68, v28
    v_xor_b32 v69, v69, v28
    v_xor_b32 v70, v70, v28
    v_xor_b32 v71, v71, v28
    v_xor_b32 v72, v72, v28
    v_xor_b32 v73, v73, v28
    v_xor_b32 v74, v74, v28
    v_xor_b32 v75, v75, v28
    v_xor_b32 v76, v76, v28
    v_xor_b32 v77, v77, v28
    v_xor_b32 v78, v78, v28
    v_xor_b32 v79, v79, v28
    v_or3_b32 v8, v64, v65, v66
    v_or3_b32 v8, v8, v67, v68
    v_or3_b32 v8, v8, v69, v70
    v_or3_b32 v8, v8, v71, v72
    v_or3_b32 v8, v8, v73, v74
    v_or3_b32 v8, v8, v75, v76
    v_or3_b32 v8, v8, v77, v78
    v_or_b32 v8, v8, v79
    v_and_b32 v8, s61, v8
    v_cmp_ne_u32 vcc, 0, v8
    s_cbranch_vccz L_qok2
    global_load_dwordx4 v[64:67], v10, s[44:45] offset:0 sc1
    global_load_dwordx4 v[68:71], v10, s[44:45] offset:1024 sc1
    global_load_dwordx4 v[72:75], v10, s[44:45] offset:2048 sc1
    global_load_dwordx4 v[76:79], v10, s[44:45] offset:3072 sc1
    s_waitcnt vmcnt(12)
    v_xor_b32 v80, v80, v28
    v_xor_b32 v81, v81, v28
    v_xor_b32 v82, v82, v28
    v_xor_b32 v83, v83, v28
    v_xor_b32 v84, v84, v28
    v_xor_b32 v85, v85, v28
    v_xor_b32 v86, v86, v28
    v_xor_b32 v87, v87, v28
    v_xor_b32 v88, v88, v28
    v_xor_b32 v89, v89, v28
    v_xor_b32 v90, v90, v28
    v_xor_b32 v91, v91, v28
    v_xor_b32 v92, v92, v28
    v_xor_b32 v93, v93, v28
    v_xor_b32 v94, v94, v28
    v_xor_b32 v95, v95, v28
    v_or3_b32 v8, v80, v81, v82
    v_or3_b32 v8, v8, v83, v84
    v_or3_b32 v8, v8, v85, v86
    v_or3_b32 v8, v8, v87, v88
    v_or3_b32 v8, v8, v89, v90
    v_or3_b32 v8, v8, v91, v92
    v_or3_b32 v8, v8, v93, v94
    v_or_b32 v8, v8, v95
    v_and_b32 v8, s61, v8
    v_cmp_ne_u32 vcc, 0, v8
    s_cbranch_vccz L_qok3
    global_load_dwordx4 v[80:83], v10, s[44:45] offset:0 sc1
    global_load_dwordx4 v[84:87], v10, s[44:45] offset:1024 sc1
    global_load_dwordx4 v[88:91], v10, s[44:45] offset:2048 sc1
    global_load_dwordx4 v[92:95], v10, s[44:45] offset:3072 sc1
    s_branch L_qp
L_qok3:
    v_pk_add_f32 v[164:165], v[80:81], v[84:85]
    v_pk_add_f32 v[166:167], v[82:83], v[86:87]
    v_pk_add_f32 v[172:173], v[88:89], v[92:93]
    v_pk_add_f32 v[174:175], v[90:91], v[94:95]
    s_branch L_qd
L_qok2:
    v_pk_add_f32 v[164:165], v[64:65], v[68:69]
    v_pk_add_f32 v[166:167], v[66:67], v[70:71]
    v_pk_add_f32 v[172:173], v[72:73], v[76:77]
    v_pk_add_f32 v[174:175], v[74:75], v[78:79]
    s_branch L_qd
L_qok1:
    v_pk_add_f32 v[164:165], v[48:49], v[52:53]
    v_pk_add_f32 v[166:167], v[50:51], v[54:55]
    v_pk_add_f32 v[172:173], v[56:57], v[60:61]
    v_pk_add_f32 v[174:175], v[58:59], v[62:63]
    s_branch L_qd
L_qok0:
    v_pk_add_f32 v[164:165], v[32:33], v[36:37]
    v_pk_add_f32 v[166:167], v[34:35], v[38:39]
    v_pk_add_f32 v[172:173], v[40:41], v[44:45]
    v_pk_add_f32 v[174:175], v[42:43], v[46:47]
L_qd:
    v_pk_add_f32 v[164:165], v[164:165], v[172:173]
    v_pk_add_f32 v[166:167], v[166:167], v[174:175]
    s_nop 1
    v_permlane32_swap_b32 v164, v166
    v_permlane32_swap_b32 v165, v167
    v_pk_add_f32 v[164:165], v[164:165], v[166:167]
    v_cvt_pk_bf16_f32 v164, v164, v165
    ds_write_b16 v29, v164 offset:0
    ds_write_b16_d16_hi v29, v164 offset:16
    s_waitcnt lgkmcnt(0)
    s_barrier
    s_mov_b64 exec, s[40:41]
    global_store_dwordx4 v31, v[160:163], s[44:45] sc1
    s_mov_b64 exec, -1
    s_lshl_b32 s35, s30, 7
    s_lshl_b32 s37, s31, 4
    s_add_u32 s35, s35, s37
    s_add_u32 s35, s35, 327680
    v_mov_b32 v27, s35
    v_and_b32 v8, 3, v0
    v_lshlrev_b32 v8, 3, v8
    v_mov_b32 v13, s34
    v_mov_b32 v15, s34
    s_barrier
    ds_read_b64 v[10:11], v8 offset:256
    s_waitcnt lgkmcnt(0)
    v_max_f32 v12, v10, v10 quad_perm:[1,0,3,2] row_mask:0xf bank_mask:0xf
    s_nop 1
    v_max_f32 v12, v12, v12 quad_perm:[2,3,0,1] row_mask:0xf bank_mask:0xf
    v_sub_f32 v10, v10, v12
    v_mul_f32 v10, s43, v10
    v_exp_f32 v10, v10
    s_nop 0
    v_mul_f32 v14, v10, v11
    s_nop 1
    v_add_f32 v14, v14, v14 quad_perm:[1,0,3,2] row_mask:0xf bank_mask:0xf
    s_nop 1
    v_add_f32 v14, v14, v14 quad_perm:[2,3,0,1] row_mask:0xf bank_mask:0xf
    s_mov_b64 exec, 1
    global_store_dwordx4 v27, v[12:15], s[28:29]
    v_add_u32 v27, 524288, v27
    global_store_dwordx4 v27, v[12:15], s[28:29] sc1
    s_mov_b64 exec, -1
    s_lshl_b32 s35, s33, 14
    s_lshl_b32 s37, s32, 19
    s_add_u32 s35, s35, s37
    v_lshl_add_u32 v8, v0, 7, s35
    global_load_dword v176, v8, s[12:13]
    v_add_u32 v8, 8192, v8
    global_load_dword v177, v8, s[12:13]
    s_min_u32 s35, s32, 3
    s_mul_i32 s54, s32, 5
    s_add_u32 s54, s54, s35
    s_cmp_lt_u32 s32, 3
    s_cselect_b32 s55, 5, 4
    s_lshl_b32 s55, s55, 6
    s_and_b32 s56, s33, 15
    s_lshl_b32 s35, s54, 6
    s_mul_i32 s37, s56, 88064
    s_add_u32 s35, s35, s37
    v_and_b32 v8, 3, v0
    v_lshlrev_b32 v8, 7, v8
    v_min_u32 v8, s55, v8
    v_lshrrev_b32 v9, 2, v0
    v_mul_u32_u24 v9, 2752, v9
    v_add3_u32 v8, v8, v9, s35
    v_add_u32 v9, 44032, v8
    s_lshl_b32 s35, s54, 15
    s_add_u32 s55, s55, 64
    s_lshl_b32 s55, s55, 5
    s_mul_i32 s37, s56, s55
    s_add_u32 s35, s35, s37
    s_sub_u32 s55, s55, 64
    v_lshlrev_b32 v10, 7, v0
    v_add_u32 v11, 8192, v10
    v_min_u32 v11, s55, v11
    v_add_u32 v10, s35, v10
    v_add_u32 v11, s35, v11
    s_barrier
    s_barrier
    s_cmp_lt_u32 s33, 16
    s_cbranch_scc1 L_nopf
    global_load_dword v20, v8, s[16:17]
    global_load_dword v21, v9, s[16:17]
    global_load_dword v22, v10, s[20:21]
    global_load_dword v23, v11, s[20:21]
L_nopf:
    s_sub_u32 s35, s2, 128
    s_cmp_lt_u32 s35, 43
    s_cbranch_scc0 L_w0e
    v_mov_b32 v167, 0
    s_mov_b64 s[40:41], 0
    s_mov_b64 s[48:49], 0
    s_mov_b64 s[58:59], 0
    s_mov_b64 exec, 0
    s_branch L_ftail
L_w0e:
    s_waitcnt vmcnt(0)
    s_endpgm
L_comp2:
    global_load_dwordx4 v[80:83], v10, s[8:9] offset:0 nt
    global_load_dwordx4 v[84:87], v10, s[8:9] offset:1024 nt
    global_load_dwordx4 v[88:91], v10, s[8:9] offset:2048 nt
    global_load_dwordx4 v[92:95], v10, s[8:9] offset:3072 nt
    s_barrier
    s_mov_b64 exec, s[46:47]
    ds_read_b128 v[160:163], v12 offset:0
    s_mov_b64 exec, s[48:49]
    ds_read_b128 v[164:167], v12 offset:0
    s_mov_b64 exec, s[50:51]
    ds_read_b128 v[168:171], v12 offset:0
    s_mov_b64 exec, s[52:53]
    ds_read_b128 v[172:175], v12 offset:0
    s_mov_b64 exec, -1
    s_waitcnt vmcnt(8) lgkmcnt(0)
    v_mfma_f32_16x16x32_bf16 v[176:179], v[32:35], v[160:163], 0
    v_mfma_f32_16x16x32_bf16 v[180:183], v[48:51], v[160:163], 0
    v_mfma_f32_16x16x32_bf16 v[176:179], v[36:39], v[164:167], v[176:179]
    v_mfma_f32_16x16x32_bf16 v[180:183], v[52:55], v[164:167], v[180:183]
    v_mfma_f32_16x16x32_bf16 v[176:179], v[40:43], v[168:171], v[176:179]
    v_mfma_f32_16x16x32_bf16 v[180:183], v[56:59], v[168:171], v[180:183]
    v_mfma_f32_16x16x32_bf16 v[176:179], v[44:47], v[172:175], v[176:179]
    v_mfma_f32_16x16x32_bf16 v[180:183], v[60:63], v[172:175], v[180:183]
    s_add_u32 s34, s34, 1
    s_nop 5
    v_mov_b32 v24, v176 quad_perm:[0,0,0,0] row_mask:0xf bank_mask:0xf
    v_mov_b32 v25, v180 quad_perm:[0,0,0,0] row_mask:0xf bank_mask:0xf
    s_nop 0
    v_add_f32 v24, v177, v24 quad_perm:[1,1,1,1] row_mask:0xf bank_mask:0xf
    v_add_f32 v25, v181, v25 quad_perm:[1,1,1,1] row_mask:0xf bank_mask:0xf
    s_nop 0
    v_add_f32 v24, v178, v24 quad_perm:[2,2,2,2] row_mask:0xf bank_mask:0xf
    v_add_f32 v25, v182, v25 quad_perm:[2,2,2,2] row_mask:0xf bank_mask:0xf
    s_nop 0
    v_add_f32 v24, v179, v24 quad_perm:[3,3,3,3] row_mask:0xf bank_mask:0xf
    v_add_f32 v25, v183, v25 quad_perm:[3,3,3,3] row_mask:0xf bank_mask:0xf
    v_cvt_pk_bf16_f32 v24, v24, v25
    v_and_b32 v25, s42, v24
    v_lshlrev_b32 v24, 16, v24
    v_mul_f32 v24, 0x3db504f3, v24
    v_mul_f32 v25, 0x3db504f3, v25
    v_cvt_pk_bf16_f32 v24, v24, v25
    v_and_b32 v25, s42, v24
    v_lshlrev_b32 v24, 16, v24
    v_max_f32 v26, v24, v25
    s_nop 1
    v_max_f32 v26, v26, v26 row_ror:4 row_mask:0xf bank_mask:0xf
    s_nop 1
    v_max_f32 v26, v26, v26 row_ror:8 row_mask:0xf bank_mask:0xf
    v_mov_b32 v27, v26
    s_nop 1
    v_permlane16_swap_b32 v26, v27
    v_max_f32 v26, v26, v27
    v_mov_b32 v27, v26
    s_nop 1
    v_permlane32_swap_b32 v26, v27
    v_max_f32 v26, v26, v27
    v_sub_f32 v28, v24, v26
    v_sub_f32 v29, v25, v26
    v_mul_f32 v28, s43, v28
    v_mul_f32 v29, s43, v29
    v_exp_f32 v28, v28
    v_exp_f32 v29, v29
    s_nop 0
    v_add_f32 v27, v28, v29
    s_nop 1
    v_add_f32 v27, v27, v27 row_ror:4 row_mask:0xf bank_mask:0xf
    s_nop 1
    v_add_f32 v27, v27, v27 row_ror:8 row_mask:0xf bank_mask:0xf
    v_mov_b32 v28, v27
    s_nop 1
    v_permlane16_swap_b32 v27, v28
    v_add_f32 v27, v27, v28
    v_mov_b32 v28, v27
    s_nop 1
    v_permlane32_swap_b32 v27, v28
    v_add_f32 v27, v27, v28
    s_mov_b64 exec, 1
    ds_write_b64 v13, v[26:27] offset:256
    s_mov_b64 exec, -1
    v_and_b32 v8, 3, v0
    v_lshlrev_b32 v8, 3, v8
    s_waitcnt lgkmcnt(0)
    s_barrier
    ds_read_b32 v26, v8 offset:256
    s_waitcnt lgkmcnt(0)
    v_max_f32 v26, v26, v26 quad_perm:[1,0,3,2] row_mask:0xf bank_mask:0xf
    s_nop 1
    v_max_f32 v26, v26, v26 quad_perm:[2,3,0,1] row_mask:0xf bank_mask:0xf
    v_sub_f32 v28, v24, v26
    v_sub_f32 v29, v25, v26
    v_mul_f32 v28, s43, v28
    v_mul_f32 v29, s43, v29
    v_exp_f32 v28, v28
    v_exp_f32 v29, v29
    v_cvt_pk_bf16_f32 v28, v28, v28
    v_cvt_pk_bf16_f32 v29, v29, v29
    s_nop 0
    v_and_b32 v32, v28, v4 row_newbcast:0 row_mask:0xf bank_mask:0xf
    v_and_b32 v33, v28, v5 row_newbcast:0 row_mask:0xf bank_mask:0xf
    v_and_b32 v34, v28, v6 row_newbcast:0 row_mask:0xf bank_mask:0xf
    v_and_b32 v35, v28, v7 row_newbcast:0 row_mask:0xf bank_mask:0xf
    v_and_b32 v36, v28, v4 row_newbcast:4 row_mask:0xf bank_mask:0xf
    v_and_b32 v37, v28, v5 row_newbcast:4 row_mask:0xf bank_mask:0xf
    v_and_b32 v38, v28, v6 row_newbcast:4 row_mask:0xf bank_mask:0xf
    v_and_b32 v39, v28, v7 row_newbcast:4 row_mask:0xf bank_mask:0xf
    v_and_b32 v40, v28, v4 row_newbcast:8 row_mask:0xf bank_mask:0xf
    v_and_b32 v41, v28, v5 row_newbcast:8 row_mask:0xf bank_mask:0xf
    v_and_b32 v42, v28, v6 row_newbcast:8 row_mask:0xf bank_mask:0xf
    v_and_b32 v43, v28, v7 row_newbcast:8 row_mask:0xf bank_mask:0xf
    v_and_b32 v44, v28, v4 row_newbcast:12 row_mask:0xf bank_mask:0xf
    v_and_b32 v45, v28, v5 row_newbcast:12 row_mask:0xf bank_mask:0xf
    v_and_b32 v46, v28, v6 row_newbcast:12 row_mask:0xf bank_mask:0xf
    v_and_b32 v47, v28, v7 row_newbcast:12 row_mask:0xf bank_mask:0xf
    v_and_b32 v48, v29, v4 row_newbcast:0 row_mask:0xf bank_mask:0xf
    v_and_b32 v49, v29, v5 row_newbcast:0 row_mask:0xf bank_mask:0xf
    v_and_b32 v50, v29, v6 row_newbcast:0 row_mask:0xf bank_mask:0xf
    v_and_b32 v51, v29, v7 row_newbcast:0 row_mask:0xf bank_mask:0xf
    v_and_b32 v52, v29, v4 row_newbcast:4 row_mask:0xf bank_mask:0xf
    v_and_b32 v53, v29, v5 row_newbcast:4 row_mask:0xf bank_mask:0xf
    v_and_b32 v54, v29, v6 row_newbcast:4 row_mask:0xf bank_mask:0xf
    v_and_b32 v55, v29, v7 row_newbcast:4 row_mask:0xf bank_mask:0xf
    v_and_b32 v56, v29, v4 row_newbcast:8 row_mask:0xf bank_mask:0xf
    v_and_b32 v57, v29, v5 row_newbcast:8 row_mask:0xf bank_mask:0xf
    v_and_b32 v58, v29, v6 row_newbcast:8 row_mask:0xf bank_mask:0xf
    v_and_b32 v59, v29, v7 row_newbcast:8 row_mask:0xf bank_mask:0xf
    v_and_b32 v60, v29, v4 row_newbcast:12 row_mask:0xf bank_mask:0xf
    v_and_b32 v61, v29, v5 row_newbcast:12 row_mask:0xf bank_mask:0xf
    v_and_b32 v62, v29, v6 row_newbcast:12 row_mask:0xf bank_mask:0xf
    v_and_b32 v63, v29, v7 row_newbcast:12 row_mask:0xf bank_mask:0xf
    s_lshl_b32 s35, s30, 12
    s_lshl_b32 s37, s31, 9
    s_add_u32 s35, s35, s37
    s_add_u32 s35, s35, 196608
    v_lshl_add_u32 v24, v0, 3, s35
    v_lshrrev_b32 v25, 1, v0
    v_add_u32 v25, s34, v25
    v_and_b32 v26, 31, v0
    v_lshrrev_b32 v27, 5, v0
    v_lshlrev_b32 v27, 10, v27
    v_lshl_add_u32 v26, v26, 4, v27
    s_waitcnt vmcnt(7)
    v_mfma_f32_16x16x32_bf16 v[184:187], v[64:67], v[32:35], 0
    s_waitcnt vmcnt(6)
    v_mfma_f32_16x16x32_bf16 v[184:187], v[68:71], v[36:39], v[184:187]
    s_waitcnt vmcnt(5)
    v_mfma_f32_16x16x32_bf16 v[184:187], v[72:75], v[40:43], v[184:187]
    s_waitcnt vmcnt(4)
    v_mfma_f32_16x16x32_bf16 v[184:187], v[76:79], v[44:47], v[184:187]
    s_waitcnt vmcnt(3)
    v_mfma_f32_16x16x32_bf16 v[184:187], v[80:83], v[48:51], v[184:187]
    s_waitcnt vmcnt(2)
    v_mfma_f32_16x16x32_bf16 v[184:187], v[84:87], v[52:55], v[184:187]
    s_waitcnt vmcnt(1)
    v_mfma_f32_16x16x32_bf16 v[184:187], v[88:91], v[56:59], v[184:187]
    s_waitcnt vmcnt(0)
    v_mfma_f32_16x16x32_bf16 v[184:187], v[92:95], v[60:63], v[184:187]
    s_mov_b64 exec, s[40:41]
    s_cmp_lg_u32 s38, 0
    s_nop 5
    ds_write_b128 v14, v[184:187] offset:512
    s_mov_b64 exec, -1
    s_waitcnt lgkmcnt(0)
    s_barrier
    s_cbranch_scc1 L_nopub_pl
    ds_read_b128 v[32:35], v26 offset:512
    ds_read_b128 v[36:39], v26 offset:1024
    s_waitcnt lgkmcnt(0)
    v_pk_add_f32 v[32:33], v[32:33], v[36:37]
    v_pk_add_f32 v[34:35], v[34:35], v[38:39]
    s_nop 1
    v_permlane32_swap_b32 v32, v34
    v_permlane32_swap_b32 v33, v35
    v_pk_add_f32 v[32:33], v[32:33], v[34:35]
    v_bfi_b32 v28, s61, v25, v32
    v_bfi_b32 v29, s61, v25, v33
    s_nop 0
    v_mov_b32 v30, v28 quad_perm:[1,1,3,3] row_mask:0xf bank_mask:0xf
    v_mov_b32 v31, v29 quad_perm:[1,1,3,3] row_mask:0xf bank_mask:0xf
    s_mov_b64 exec, s[62:63]
    global_store_dwordx4 v24, v[28:31], s[28:29]
    v_add_u32 v24, 524288, v24
    global_store_dwordx4 v24, v[28:31], s[28:29] sc1
    s_mov_b64 exec, -1
L_nopub_pl:
    s_barrier
    s_sub_u32 s39, s2, 192
    s_cmp_lt_u32 s39, 32
    s_cselect_b32 s35, 1, 99
    s_cmp_eq_u32 s38, s35
    s_cbranch_scc0 L_rdry
    s_lshr_b32 s54, s39, 1
    s_and_b32 s55, s39, 1
    v_and_b32 v9, 3, v0
    s_lshl_b32 s35, s54, 5
    s_lshl_b32 s37, s55, 2
    s_add_u32 s35, s35, s37
    v_lshl_add_u32 v8, v1, 3, v9
    v_add_u32 v8, s35, v8
    v_lshlrev_b32 v16, 1, v8
    v_mov_b32 v20, 0
    v_mov_b32 v21, 0
    global_load_short_d16_hi v20, v16, s[4:5]
    global_load_short_d16_hi v21, v16, s[22:23]
    s_lshr_b32 s35, s54, 1
    s_lshl_b32 s35, s35, 12
    s_and_b32 s37, s39, 3
    s_lshl_b32 s57, s37, 4
    s_add_u32 s35, s35, s57
    s_add_u32 s35, s35, 393216
    v_lshrrev_b32 v8, 2, v2
    v_lshl_add_u32 v8, v8, 8, s35
    v_lshl_add_u32 v8, v1, 6, v8
    v_lshl_add_u32 v17, v9, 2, v8
    s_add_u32 s37, s37, s34
    v_lshl_add_u32 v8, v1, 2, s37
    v_and_b32 v18, s61, v8
    s_mul_i32 s35, s54, 6144
    s_lshl_b32 s37, s55, 6
    s_add_u32 s35, s35, s37
    s_add_u32 s35, s35, 460800
    v_lshrrev_b32 v8, 2, v0
    v_lshl_add_u32 v8, v8, 7, s35
    v_lshl_add_u32 v19, v9, 4, v8
    s_lshl_b32 s37, s55, 2
    s_add_u32 s37, s37, s34
    v_add_u32 v8, s37, v9
    v_and_b32 v22, s61, v8
    s_mov_b32 s58, -1
    s_mov_b32 s59, 0xfff
    s_mov_b32 s36, 200000
L_rh1:
    global_load_dword v32, v17, s[28:29] offset:0 sc1
    global_load_dword v33, v17, s[28:29] offset:1024 sc1
    global_load_dword v34, v17, s[28:29] offset:2048 sc1
    global_load_dword v35, v17, s[28:29] offset:3072 sc1
    s_waitcnt vmcnt(0)
    v_xor_b32 v32, v32, v18
    v_xor_b32 v33, v33, v18
    v_xor_b32 v34, v34, v18
    v_xor_b32 v35, v35, v18
    v_or3_b32 v8, v32, v33, v34
    v_or_b32 v8, v8, v35
    v_and_b32 v8, s61, v8
    v_cmp_ne_u32 vcc, 0, v8
    s_cbranch_vccnz L_rh1_r
L_rh1_d:
    v_add_f32 v32, v32, v33
    v_add_f32 v34, v34, v35
    v_add_f32 v32, v32, v34
    s_nop 1
    v_add_f32 v32, v32, v32 row_ror:4 row_mask:0xf bank_mask:0xf
    s_nop 1
    v_add_f32 v32, v32, v32 row_ror:8 row_mask:0xf bank_mask:0xf
    v_cvt_pk_bf16_f32 v32, v32, v32
    v_lshlrev_b32 v32, 16, v32
    v_add_f32 v20, v20, v32
    v_cvt_pk_bf16_f32 v20, v20, v20
    v_and_b32 v20, s42, v20
    s_mov_b32 s37, 200000
    v_mov_b32 v56, v22
    v_mov_b32 v57, v22
    v_mov_b32 v58, v22
    v_mov_b32 v59, v22
    global_load_dwordx4 v[48:51], v19, s[28:29] offset:-2048 sc1
    global_load_dwordx4 v[52:55], v19, s[28:29] sc1
    s_mov_b64 exec, s[58:59]
    global_load_dwordx4 v[56:59], v19, s[28:29] offset:2048 sc1
    s_mov_b64 exec, -1
    s_sleep 3
    s_branch L_rp_e
L_rp_l:
    v_mov_b32 v56, v22
    v_mov_b32 v57, v22
    v_mov_b32 v58, v22
    v_mov_b32 v59, v22
    global_load_dwordx4 v[48:51], v19, s[28:29] offset:-2048 sc1
    global_load_dwordx4 v[52:55], v19, s[28:29] sc1
    s_mov_b64 exec, s[58:59]
    global_load_dwordx4 v[56:59], v19, s[28:29] offset:2048 sc1
    s_mov_b64 exec, -1
    s_waitcnt vmcnt(3)
    v_xor_b32 v64, v64, v22
    v_xor_b32 v65, v65, v22
    v_xor_b32 v66, v66, v22
    v_xor_b32 v67, v67, v22
    v_xor_b32 v68, v68, v22
    v_xor_b32 v69, v69, v22
    v_xor_b32 v70, v70, v22
    v_xor_b32 v71, v71, v22
    v_xor_b32 v72, v72, v22
    v_xor_b32 v73, v73, v22
    v_xor_b32 v74, v74, v22
    v_xor_b32 v75, v75, v22
    v_or3_b32 v8, v64, v65, v66
    v_or3_b32 v8, v8, v67, v68
    v_or3_b32 v8, v8, v69, v70
    v_or3_b32 v8, v8, v71, v72
    v_or3_b32 v8, v8, v73, v74
    v_or_b32 v8, v8, v75
    v_and_b32 v8, s61, v8
    v_cmp_ne_u32 vcc, 0, v8
    s_cbranch_vccz L_rp_b
    s_sub_u32 s37, s37, 1
    s_cbranch_scc1 L_rp_x
L_rp_e:
    v_mov_b32 v72, v22
    v_mov_b32 v73, v22
    v_mov_b32 v74, v22
    v_mov_b32 v75, v22
    global_load_dwordx4 v[64:67], v19, s[28:29] offset:-2048 sc1
    global_load_dwordx4 v[68:71], v19, s[28:29] sc1
    s_mov_b64 exec, s[58:59]
    global_load_dwordx4 v[72:75], v19, s[28:29] offset:2048 sc1
    s_mov_b64 exec, -1
    s_waitcnt vmcnt(3)
    v_xor_b32 v48, v48, v22
    v_xor_b32 v49, v49, v22
    v_xor_b32 v50, v50, v22
    v_xor_b32 v51, v51, v22
    v_xor_b32 v52, v52, v22
    v_xor_b32 v53, v53, v22
    v_xor_b32 v54, v54, v22
    v_xor_b32 v55, v55, v22
    v_xor_b32 v56, v56, v22
    v_xor_b32 v57, v57, v22
    v_xor_b32 v58, v58, v22
    v_xor_b32 v59, v59, v22
    v_or3_b32 v8, v48, v49, v50
    v_or3_b32 v8, v8, v51, v52
    v_or3_b32 v8, v8, v53, v54
    v_or3_b32 v8, v8, v55, v56
    v_or3_b32 v8, v8, v57, v58
    v_or_b32 v8, v8, v59
    v_and_b32 v8, s61, v8
    v_cmp_ne_u32 vcc, 0, v8
    s_cbranch_vccnz L_rp_l
L_rp_a:
    v_pk_add_f32 v[32:33], v[48:49], v[52:53]
    v_pk_add_f32 v[34:35], v[50:51], v[54:55]
    v_pk_add_f32 v[32:33], v[32:33], v[56:57]
    v_pk_add_f32 v[34:35], v[34:35], v[58:59]
L_rp_c:
    s_nop 0
    v_permlane16_swap_b32 v32, v33
    v_permlane16_swap_b32 v34, v35
    v_add_f32 v32, v32, v33
    v_add_f32 v34, v34, v35
    s_nop 1
    v_permlane32_swap_b32 v32, v34
    v_add_f32 v32, v32, v34
    s_nop 1
    v_add_f32 v32, v32, v32 row_ror:4 row_mask:0xf bank_mask:0xf
    s_nop 1
    v_add_f32 v32, v32, v32 row_ror:8 row_mask:0xf bank_mask:0xf
    v_cvt_pk_bf16_f32 v32, v32, v32
    v_lshlrev_b32 v32, 16, v32
    v_add_f32 v32, v32, v21
    v_cvt_pk_bf16_f32 v32, v32, v32
    v_lshlrev_b32 v32, 16, v32
    v_add_f32 v32, v32, v20
    v_cvt_pk_bf16_f32 v32, v32, v32
    s_mov_b64 exec, s[46:47]
    global_store_short v16, v32, s[24:25]
    s_cmp_lg_u32 s39, 0
    s_cbranch_scc1 L_fin
    s_mov_b64 exec, 1
    v_mov_b32 v8, 0
    v_mov_b32 v9, s34
    global_store_dword v8, v9, s[28:29]
    s_branch L_fin
L_att_wo:
    s_and_b32 s54, s33, 1
    s_lshl_b32 s35, s32, 1
    s_add_u32 s56, s54, s35
    s_lshl_b32 s54, s56, 1
    s_lshr_b32 s35, s38, 1
    s_add_u32 s54, s54, s35
    s_lshr_b32 s55, s33, 1
    s_lshl_b32 s35, s54, 17
    s_and_b32 s37, s38, 1
    s_lshl_b32 s37, s37, 14
    s_add_u32 s35, s35, s37
    s_lshl_b32 s37, s55, 7
    s_add_u32 s35, s35, s37
    s_add_u32 s35, s35, 4096
    s_add_u32 s12, s12, s35
    s_addc_u32 s13, s13, 0
    v_lshrrev_b32 v8, 3, v2
    v_lshlrev_b32 v8, 5, v8
    v_and_b32 v9, 1, v1
    v_lshl_add_u32 v8, v9, 3, v8
    v_lshrrev_b32 v9, 1, v1
    v_add_u32 v8, v8, v9
    v_lshlrev_b32 v8, 10, v8
    v_and_b32 v9, 7, v0
    v_lshl_add_u32 v16, v9, 4, v8
    v_add_u32 v17, 0x10000, v16
    global_load_dwordx4 v[80:83], v10, s[8:9] offset:0 nt
    global_load_dwordx4 v[84:87], v10, s[8:9] offset:1024 nt
    global_load_dwordx4 v[88:91], v10, s[8:9] offset:2048 nt
    global_load_dwordx4 v[92:95], v10, s[8:9] offset:3072 nt
    s_barrier
    s_mov_b64 exec, s[46:47]
    ds_read_b128 v[160:163], v12 offset:0
    s_mov_b64 exec, s[48:49]
    ds_read_b128 v[164:167], v12 offset:0
    s_mov_b64 exec, s[50:51]
    ds_read_b128 v[168:171], v12 offset:0
    s_mov_b64 exec, s[52:53]
    ds_read_b128 v[172:175], v12 offset:0
    s_mov_b64 exec, -1
    s_waitcnt vmcnt(8) lgkmcnt(0)
    v_mfma_f32_16x16x32_bf16 v[176:179], v[32:35], v[160:163], 0
    v_mfma_f32_16x16x32_bf16 v[180:183], v[48:51], v[160:163], 0
    v_mfma_f32_16x16x32_bf16 v[176:179], v[36:39], v[164:167], v[176:179]
    v_mfma_f32_16x16x32_bf16 v[180:183], v[52:55], v[164:167], v[180:183]
    v_mfma_f32_16x16x32_bf16 v[176:179], v[40:43], v[168:171], v[176:179]
    v_mfma_f32_16x16x32_bf16 v[180:183], v[56:59], v[168:171], v[180:183]
    v_mfma_f32_16x16x32_bf16 v[176:179], v[44:47], v[172:175], v[176:179]
    v_mfma_f32_16x16x32_bf16 v[180:183], v[60:63], v[172:175], v[180:183]
    s_add_u32 s34, s34, 1
    s_nop 5
    v_mov_b32 v24, v176 quad_perm:[0,0,0,0] row_mask:0xf bank_mask:0xf
    v_mov_b32 v25, v180 quad_perm:[0,0,0,0] row_mask:0xf bank_mask:0xf
    s_nop 0
    v_add_f32 v24, v177, v24 quad_perm:[1,1,1,1] row_mask:0xf bank_mask:0xf
    v_add_f32 v25, v181, v25 quad_perm:[1,1,1,1] row_mask:0xf bank_mask:0xf
    s_nop 0
    v_add_f32 v24, v178, v24 quad_perm:[2,2,2,2] row_mask:0xf bank_mask:0xf
    v_add_f32 v25, v182, v25 quad_perm:[2,2,2,2] row_mask:0xf bank_mask:0xf
    s_nop 0
    v_add_f32 v24, v179, v24 quad_perm:[3,3,3,3] row_mask:0xf bank_mask:0xf
    v_add_f32 v25, v183, v25 quad_perm:[3,3,3,3] row_mask:0xf bank_mask:0xf
    v_cvt_pk_bf16_f32 v24, v24, v25
    v_and_b32 v25, s42, v24
    v_lshlrev_b32 v24, 16, v24
    v_mul_f32 v24, 0x3db504f3, v24
    v_mul_f32 v25, 0x3db504f3, v25
    v_cvt_pk_bf16_f32 v24, v24, v25
    v_and_b32 v25, s42, v24
    v_lshlrev_b32 v24, 16, v24
    v_max_f32 v26, v24, v25
    s_nop 1
    v_max_f32 v26, v26, v26 row_ror:4 row_mask:0xf bank_mask:0xf
    s_nop 1
    v_max_f32 v26, v26, v26 row_ror:8 row_mask:0xf bank_mask:0xf
    v_mov_b32 v27, v26
    s_nop 1
    v_permlane16_swap_b32 v26, v27
    v_max_f32 v26, v26, v27
    v_mov_b32 v27, v26
    s_nop 1
    v_permlane32_swap_b32 v26, v27
    v_max_f32 v26, v26, v27
    v_sub_f32 v28, v24, v26
    v_sub_f32 v29, v25, v26
    v_mul_f32 v28, s43, v28
    v_mul_f32 v29, s43, v29
    v_exp_f32 v28, v28
    v_exp_f32 v29, v29
    s_nop 0
    v_add_f32 v27, v28, v29
    s_nop 1
    v_add_f32 v27, v27, v27 row_ror:4 row_mask:0xf bank_mask:0xf
    s_nop 1
    v_add_f32 v27, v27, v27 row_ror:8 row_mask:0xf bank_mask:0xf
    v_mov_b32 v28, v27
    s_nop 1
    v_permlane16_swap_b32 v27, v28
    v_add_f32 v27, v27, v28
    v_mov_b32 v28, v27
    s_nop 1
    v_permlane32_swap_b32 v27, v28
    v_add_f32 v27, v27, v28
    s_mov_b64 exec, 1
    ds_write_b64 v13, v[26:27] offset:256
    s_mov_b64 exec, -1
    v_and_b32 v8, 3, v0
    v_lshlrev_b32 v8, 3, v8
    s_waitcnt lgkmcnt(0)
    s_barrier
    ds_read_b32 v26, v8 offset:256
    s_waitcnt lgkmcnt(0)
    v_max_f32 v26, v26, v26 quad_perm:[1,0,3,2] row_mask:0xf bank_mask:0xf
    s_nop 1
    v_max_f32 v26, v26, v26 quad_perm:[2,3,0,1] row_mask:0xf bank_mask:0xf
    v_sub_f32 v28, v24, v26
    v_sub_f32 v29, v25, v26
    v_mul_f32 v28, s43, v28
    v_mul_f32 v29, s43, v29
    v_exp_f32 v28, v28
    v_exp_f32 v29, v29
    v_cvt_pk_bf16_f32 v28, v28, v28
    v_cvt_pk_bf16_f32 v29, v29, v29
    s_nop 0
    v_and_b32 v32, v28, v4 row_newbcast:0 row_mask:0xf bank_mask:0xf
    v_and_b32 v33, v28, v5 row_newbcast:0 row_mask:0xf bank_mask:0xf
    v_and_b32 v34, v28, v6 row_newbcast:0 row_mask:0xf bank_mask:0xf
    v_and_b32 v35, v28, v7 row_newbcast:0 row_mask:0xf bank_mask:0xf
    v_and_b32 v36, v28, v4 row_newbcast:4 row_mask:0xf bank_mask:0xf
    v_and_b32 v37, v28, v5 row_newbcast:4 row_mask:0xf bank_mask:0xf
    v_and_b32 v38, v28, v6 row_newbcast:4 row_mask:0xf bank_mask:0xf
    v_and_b32 v39, v28, v7 row_newbcast:4 row_mask:0xf bank_mask:0xf
    v_and_b32 v40, v28, v4 row_newbcast:8 row_mask:0xf bank_mask:0xf
    v_and_b32 v41, v28, v5 row_newbcast:8 row_mask:0xf bank_mask:0xf
    v_and_b32 v42, v28, v6 row_newbcast:8 row_mask:0xf bank_mask:0xf
    v_and_b32 v43, v28, v7 row_newbcast:8 row_mask:0xf bank_mask:0xf
    v_and_b32 v44, v28, v4 row_newbcast:12 row_mask:0xf bank_mask:0xf
    v_and_b32 v45, v28, v5 row_newbcast:12 row_mask:0xf bank_mask:0xf
    v_and_b32 v46, v28, v6 row_newbcast:12 row_mask:0xf bank_mask:0xf
    v_and_b32 v47, v28, v7 row_newbcast:12 row_mask:0xf bank_mask:0xf
    v_and_b32 v48, v29, v4 row_newbcast:0 row_mask:0xf bank_mask:0xf
    v_and_b32 v49, v29, v5 row_newbcast:0 row_mask:0xf bank_mask:0xf
    v_and_b32 v50, v29, v6 row_newbcast:0 row_mask:0xf bank_mask:0xf
    v_and_b32 v51, v29, v7 row_newbcast:0 row_mask:0xf bank_mask:0xf
    v_and_b32 v52, v29, v4 row_newbcast:4 row_mask:0xf bank_mask:0xf
    v_and_b32 v53, v29, v5 row_newbcast:4 row_mask:0xf bank_mask:0xf
    v_and_b32 v54, v29, v6 row_newbcast:4 row_mask:0xf bank_mask:0xf
    v_and_b32 v55, v29, v7 row_newbcast:4 row_mask:0xf bank_mask:0xf
    v_and_b32 v56, v29, v4 row_newbcast:8 row_mask:0xf bank_mask:0xf
    v_and_b32 v57, v29, v5 row_newbcast:8 row_mask:0xf bank_mask:0xf
    v_and_b32 v58, v29, v6 row_newbcast:8 row_mask:0xf bank_mask:0xf
    v_and_b32 v59, v29, v7 row_newbcast:8 row_mask:0xf bank_mask:0xf
    v_and_b32 v60, v29, v4 row_newbcast:12 row_mask:0xf bank_mask:0xf
    v_and_b32 v61, v29, v5 row_newbcast:12 row_mask:0xf bank_mask:0xf
    v_and_b32 v62, v29, v6 row_newbcast:12 row_mask:0xf bank_mask:0xf
    v_and_b32 v63, v29, v7 row_newbcast:12 row_mask:0xf bank_mask:0xf
    global_load_dwordx4 v[96:99], v16, s[12:13] offset:-4096
    global_load_dwordx4 v[100:103], v16, s[12:13] offset:-2048
    global_load_dwordx4 v[104:107], v16, s[12:13] offset:0
    global_load_dwordx4 v[108:111], v16, s[12:13] offset:2048
    s_lshl_b32 s35, s30, 12
    s_lshl_b32 s37, s31, 9
    s_add_u32 s35, s35, s37
    s_add_u32 s35, s35, 196608
    v_lshl_add_u32 v24, v0, 3, s35
    v_lshrrev_b32 v25, 1, v0
    v_add_u32 v25, s34, v25
    v_and_b32 v26, 31, v0
    v_lshrrev_b32 v27, 5, v0
    v_lshlrev_b32 v27, 10, v27
    v_lshl_add_u32 v26, v26, 4, v27
    s_lshl_b32 s35, s54, 7
    s_add_u32 s35, s35, 327680
    v_lshrrev_b32 v8, 3, v0
    v_lshl_add_u32 v160, v8, 4, s35
    s_lshl_b32 s35, s54, 12
    s_and_b32 s37, s38, 1
    s_lshl_b32 s37, s37, 8
    s_add_u32 s35, s35, s37
    s_add_u32 s35, s35, 196608
    v_lshl_add_u32 v8, v8, 9, s35
    v_and_b32 v9, 7, v0
    v_lshl_add_u32 v161, v9, 4, v8
    s_lshr_b32 s37, s37, 4
    s_add_u32 s37, s37, s34
    v_add_u32 v9, s37, v9
    v_and_b32 v162, s61, v9
    v_add_u32 v9, 8, v9
    v_and_b32 v163, s61, v9
    v_lshrrev_b32 v8, 1, v1
    s_lshl_b32 s35, s38, 9
    v_lshl_add_u32 v8, v8, 8, s35
    v_and_b32 v9, 1, v1
    v_lshl_add_u32 v9, v9, 3, v3
    v_lshl_add_u32 v164, v9, 4, v8
    v_lshlrev_b32 v8, 9, v1
    v_lshl_add_u32 v165, v2, 4, v8
    s_lshl_b32 s35, s55, 12
    s_lshl_b32 s37, s56, 8
    s_add_u32 s35, s35, s37
    s_add_u32 s35, s35, 393216
    v_lshl_add_u32 v166, v0, 2, s35
    v_lshrrev_b32 v8, 2, v0
    v_add_u32 v167, s34, v8
    s_mov_b32 s58, 0x0f0f0f0f
    s_mov_b32 s59, 0xf0f0f0f0
    s_cmp_eq_u32 s38, 0
    s_cselect_b64 s[50:51], s[62:63], 0
    s_mov_b32 s52, 0
    v_and_b32 v8, 1, v0
    v_bfe_u32 v9, v0, 1, 1
    v_lshl_add_u32 v8, v8, 2, v9
    v_and_b32 v9, 1, v1
    v_lshl_add_u32 v8, v9, 1, v8
    s_lshl_b32 s35, s55, 11
    s_lshl_b32 s37, s56, 7
    s_add_u32 s35, s35, s37
    s_add_u32 s35, s35, 425984
    v_lshl_add_u32 v168, v8, 4, s35
    v_add_u32 v8, s34, v8
    v_bfe_u32 v9, v0, 2, 2
    v_lshrrev_b32 v169, 5, v0
    v_lshl_add_u32 v9, v169, 2, v9
    v_bfe_u32 v8, v8, v9, 1
    v_lshlrev_b32 v169, 16, v8
    s_mov_b32 s53, 0xfffe0000
    s_mov_b32 s57, 0x07060302
    s_waitcnt vmcnt(11)
    v_mfma_f32_16x16x32_bf16 v[184:187], v[64:67], v[32:35], 0
    s_waitcnt vmcnt(10)
    v_mfma_f32_16x16x32_bf16 v[184:187], v[68:71], v[36:39], v[184:187]
    s_waitcnt vmcnt(9)
    v_mfma_f32_16x16x32_bf16 v[184:187], v[72:75], v[40:43], v[184:187]
    s_waitcnt vmcnt(8)
    v_mfma_f32_16x16x32_bf16 v[184:187], v[76:79], v[44:47], v[184:187]
    global_load_dwordx4 v[112:115], v17, s[12:13] offset:-4096
    s_waitcnt vmcnt(8)
    v_mfma_f32_16x16x32_bf16 v[184:187], v[80:83], v[48:51], v[184:187]
    global_load_dwordx4 v[116:119], v17, s[12:13] offset:-2048
    s_waitcnt vmcnt(8)
    v_mfma_f32_16x16x32_bf16 v[184:187], v[84:87], v[52:55], v[184:187]
    global_load_dwordx4 v[120:123], v17, s[12:13] offset:0
    s_waitcnt vmcnt(8)
    v_mfma_f32_16x16x32_bf16 v[184:187], v[88:91], v[56:59], v[184:187]
    global_load_dwordx4 v[124:127], v17, s[12:13] offset:2048
    s_waitcnt vmcnt(8)
    v_mfma_f32_16x16x32_bf16 v[184:187], v[92:95], v[60:63], v[184:187]
    global_load_dwordx4 v[40:43], v160, s[28:29] sc1
    s_mov_b64 exec, s[40:41]
    s_cmp_lg_u32 s38, 0
    s_nop 4
    ds_write_b128 v14, v[184:187] offset:512
    s_mov_b64 exec, -1
    s_waitcnt lgkmcnt(0)
    s_barrier
    s_cbranch_scc1 L_nopub_wo
    ds_read_b128 v[32:35], v26 offset:512
    ds_read_b128 v[36:39], v26 offset:1024
    s_waitcnt lgkmcnt(0)
    v_pk_add_f32 v[32:33], v[32:33], v[36:37]
    v_pk_add_f32 v[34:35], v[34:35], v[38:39]
    s_nop 1
    v_permlane32_swap_b32 v32, v34
    v_permlane32_swap_b32 v33, v35
    v_pk_add_f32 v[32:33], v[32:33], v[34:35]
    v_bfi_b32 v28, s61, v25, v32
    v_bfi_b32 v29, s61, v25, v33
    s_nop 0
    v_mov_b32 v30, v28 quad_perm:[1,1,3,3] row_mask:0xf bank_mask:0xf
    v_mov_b32 v31, v29 quad_perm:[1,1,3,3] row_mask:0xf bank_mask:0xf
    s_mov_b64 exec, s[62:63]
    global_store_dwordx4 v24, v[28:31], s[28:29]
    v_add_u32 v24, 524288, v24
    s_mov_b64 exec, -1
L_nopub_wo:
    s_barrier
    s_mov_b32 s36, 200000
L_wp:
    global_load_dwordx4 v[48:51], v161, s[28:29] sc1
    global_load_dwordx4 v[52:55], v161, s[28:29] offset:128 sc1
    s_waitcnt vmcnt(2)
    v_mov_b32 v44, v40
    v_xor_b32 v41, s34, v41
    v_xor_b32 v43, s34, v43
    v_max_f32 v44, v44, v44 row_ror:8 row_mask:0xf bank_mask:0xf
    v_mov_b32 v45, v44
    s_nop 1
    v_permlane16_swap_b32 v44, v45
    v_max_f32 v44, v44, v45
    v_mov_b32 v45, v44
    s_nop 1
    v_permlane32_swap_b32 v44, v45
    v_max_f32 v44, v44, v45
    v_sub_f32 v40, v40, v44
    v_mul_f32 v40, s43, v40
    v_exp_f32 v40, v40
    v_or_b32 v41, v41, v43
    v_cmp_ne_u32 s[48:49], 0, v41
    v_mul_f32 v44, v40, v42
    s_nop 1
    v_add_f32 v44, v44, v44 row_ror:8 row_mask:0xf bank_mask:0xf
    v_mov_b32 v45, v44
    s_nop 1
    v_permlane16_swap_b32 v44, v45
    v_add_f32 v44, v44, v45
    v_mov_b32 v45, v44
    s_nop 1
    v_permlane32_swap_b32 v44, v45
    v_add_f32 v44, v44, v45
    v_rcp_f32 v44, v44
    s_waitcnt vmcnt(0)
    v_xor_b32 v48, v48, v162
    v_xor_b32 v49, v49, v162
    v_xor_b32 v50, v50, v162
    v_xor_b32 v51, v51, v162
    v_xor_b32 v52, v52, v163
    v_xor_b32 v53, v53, v163
    v_xor_b32 v54, v54, v163
    v_xor_b32 v55, v55, v163
    v_or3_b32 v8, v48, v49, v50
    v_or3_b32 v8, v8, v51, v52
    v_or3_b32 v8, v8, v53, v54
    v_or_b32 v8, v8, v55
    v_and_b32 v8, s61, v8
    v_cmp_ne_u32 vcc, 0, v8
    v_mul_f32 v40, v40, v44
    s_or_b64 vcc, vcc, s[48:49]
    s_cbranch_vccz L_wp_d
    s_or_b32 s48, s48, s49
    s_or_b32 s48, s48, s52
    s_cbranch_scc1 L_wp_r
    s_mov_b32 s52, 1
    s_mov_b32 s37, 12
    global_load_dwordx4 v[48:51], v161, s[28:29] sc1
    global_load_dwordx4 v[52:55], v161, s[28:29] offset:128 sc1
    s_sleep 2
    s_branch L_wq_e
L_wq_l:
    global_load_dwordx4 v[48:51], v161, s[28:29] sc1
    global_load_dwordx4 v[52:55], v161, s[28:29] offset:128 sc1
    s_waitcnt vmcnt(2)
    v_xor_b32 v56, v56, v162
    v_xor_b32 v57, v57, v162
    v_xor_b32 v58, v58, v162
    v_xor_b32 v59, v59, v162
    v_xor_b32 v60, v60, v163
    v_xor_b32 v61, v61, v163
    v_xor_b32 v62, v62, v163
    v_xor_b32 v63, v63, v163
    v_or3_b32 v8, v56, v57, v58
    v_or3_b32 v8, v8, v59, v60
    v_or3_b32 v8, v8, v61, v62
    v_or_b32 v8, v8, v63
    v_and_b32 v8, s61, v8
    v_cmp_ne_u32 vcc, 0, v8
    s_cbranch_vccz L_wq_b
    s_sub_u32 s37, s37, 1
    s_cbranch_scc1 L_wq_x
L_wq_e:
    global_load_dwordx4 v[56:59], v161, s[28:29] sc1
    global_load_dwordx4 v[60:63], v161, s[28:29] offset:128 sc1
    s_waitcnt vmcnt(2)
    v_xor_b32 v48, v48, v162
    v_xor_b32 v49, v49, v162
    v_xor_b32 v50, v50, v162
    v_xor_b32 v51, v51, v162
    v_xor_b32 v52, v52, v163
    v_xor_b32 v53, v53, v163
    v_xor_b32 v54, v54, v163
    v_xor_b32 v55, v55, v163
    v_or3_b32 v8, v48, v49, v50
    v_or3_b32 v8, v8, v51, v52
    v_or3_b32 v8, v8, v53, v54
    v_or_b32 v8, v8, v55
    v_and_b32 v8, s61, v8
    v_cmp_ne_u32 vcc, 0, v8
    s_cbranch_vccnz L_wq_l
L_wp_d:
    v_pk_mul_f32 v[32:33], v[48:49], v[40:41] op_sel_hi:[1,0]
    v_pk_mul_f32 v[34:35], v[50:51], v[40:41] op_sel_hi:[1,0]
    v_pk_mul_f32 v[36:37], v[52:53], v[40:41] op_sel_hi:[1,0]
    v_pk_mul_f32 v[38:39], v[54:55], v[40:41] op_sel_hi:[1,0]
L_wq_c:
    v_permlane16_swap_b32 v32, v33
    v_permlane16_swap_b32 v34, v35
    v_permlane16_swap_b32 v36, v37
    v_permlane16_swap_b32 v38, v39
    v_add_f32 v32, v32, v33
    v_add_f32 v34, v34, v35
    v_add_f32 v36, v36, v37
    v_add_f32 v38, v38, v39
    v_permlane32_swap_b32 v32, v34
    s_nop 0
    v_permlane32_swap_b32 v36, v38
    v_add_f32 v32, v32, v34
    v_add_f32 v36, v36, v38
    s_nop 0
    v_add_f32 v32, v32, v32 row_ror:8 row_mask:0xf bank_mask:0xf
    v_add_f32 v36, v36, v36 row_ror:8 row_mask:0xf bank_mask:0xf
    v_cvt_pk_bf16_f32 v32, v32, v32
    v_cvt_pk_bf16_f32 v36, v36, v36
    s_nop 0
    v_and_b32 v64, v32, v4 quad_perm:[0,0,0,0] row_mask:0xf bank_mask:0xf
    v_and_b32 v65, v32, v5 quad_perm:[0,0,0,0] row_mask:0xf bank_mask:0xf
    v_and_b32 v66, v32, v6 quad_perm:[0,0,0,0] row_mask:0xf bank_mask:0xf
    v_and_b32 v67, v32, v7 quad_perm:[0,0,0,0] row_mask:0xf bank_mask:0xf
    v_and_b32 v68, v32, v4 quad_perm:[1,1,1,1] row_mask:0xf bank_mask:0xf
    v_and_b32 v69, v32, v5 quad_perm:[1,1,1,1] row_mask:0xf bank_mask:0xf
    v_and_b32 v70, v32, v6 quad_perm:[1,1,1,1] row_mask:0xf bank_mask:0xf
    v_and_b32 v71, v32, v7 quad_perm:[1,1,1,1] row_mask:0xf bank_mask:0xf
    v_mfma_f32_16x16x32_bf16 v[184:187], v[96:99], v[64:67], 0
    v_and_b32 v72, v32, v4 quad_perm:[2,2,2,2] row_mask:0xf bank_mask:0xf
    v_and_b32 v73, v32, v5 quad_perm:[2,2,2,2] row_mask:0xf bank_mask:0xf
    v_and_b32 v74, v32, v6 quad_perm:[2,2,2,2] row_mask:0xf bank_mask:0xf
    v_and_b32 v75, v32, v7 quad_perm:[2,2,2,2] row_mask:0xf bank_mask:0xf
    v_mfma_f32_16x16x32_bf16 v[184:187], v[100:103], v[68:71], v[184:187]
    v_and_b32 v76, v32, v4 quad_perm:[3,3,3,3] row_mask:0xf bank_mask:0xf
    v_and_b32 v77, v32, v5 quad_perm:[3,3,3,3] row_mask:0xf bank_mask:0xf
    v_and_b32 v78, v32, v6 quad_perm:[3,3,3,3] row_mask:0xf bank_mask:0xf
    v_and_b32 v79, v32, v7 quad_perm:[3,3,3,3] row_mask:0xf bank_mask:0xf
    v_mfma_f32_16x16x32_bf16 v[184:187], v[104:107], v[72:75], v[184:187]
    v_and_b32 v80, v36, v4 quad_perm:[0,0,0,0] row_mask:0xf bank_mask:0xf
    v_and_b32 v81, v36, v5 quad_perm:[0,0,0,0] row_mask:0xf bank_mask:0xf
    v_and_b32 v82, v36, v6 quad_perm:[0,0,0,0] row_mask:0xf bank_mask:0xf
    v_and_b32 v83, v36, v7 quad_perm:[0,0,0,0] row_mask:0xf bank_mask:0xf
    v_mfma_f32_16x16x32_bf16 v[184:187], v[108:111], v[76:79], v[184:187]
    v_and_b32 v84, v36, v4 quad_perm:[1,1,1,1] row_mask:0xf bank_mask:0xf
    v_and_b32 v85, v36, v5 quad_perm:[1,1,1,1] row_mask:0xf bank_mask:0xf
    v_and_b32 v86, v36, v6 quad_perm:[1,1,1,1] row_mask:0xf bank_mask:0xf
    v_and_b32 v87, v36, v7 quad_perm:[1,1,1,1] row_mask:0xf bank_mask:0xf
    v_mfma_f32_16x16x32_bf16 v[184:187], v[112:115], v[80:83], v[184:187]
    v_and_b32 v88, v36, v4 quad_perm:[2,2,2,2] row_mask:0xf bank_mask:0xf
    v_and_b32 v89, v36, v5 quad_perm:[2,2,2,2] row_mask:0xf bank_mask:0xf
    v_and_b32 v90, v36, v6 quad_perm:[2,2,2,2] row_mask:0xf bank_mask:0xf
    v_and_b32 v91, v36, v7 quad_perm:[2,2,2,2] row_mask:0xf bank_mask:0xf
    v_mfma_f32_16x16x32_bf16 v[184:187], v[116:119], v[84:87], v[184:187]
    v_and_b32 v92, v36, v4 quad_perm:[3,3,3,3] row_mask:0xf bank_mask:0xf
    v_and_b32 v93, v36, v5 quad_perm:[3,3,3,3] row_mask:0xf bank_mask:0xf
    v_and_b32 v94, v36, v6 quad_perm:[3,3,3,3] row_mask:0xf bank_mask:0xf
    v_and_b32 v95, v36, v7 quad_perm:[3,3,3,3] row_mask:0xf bank_mask:0xf
    v_mfma_f32_16x16x32_bf16 v[184:187], v[120:123], v[88:91], v[184:187]
    s_nop 0
    v_mfma_f32_16x16x32_bf16 v[184:187], v[124:127], v[92:95], v[184:187]
    s_mov_b64 exec, s[58:59]
    s_cmp_lg_u32 s38, 0
    s_nop 5
    ds_write_b128 v164, v[184:187] offset:2560
    s_mov_b64 exec, s[50:51]
    global_store_dwordx4 v24, v[28:31], s[28:29] sc1
    s_mov_b64 exec, -1
    s_mov_b64 exec, -1
    s_waitcnt lgkmcnt(0)
    s_barrier
    s_cbranch_scc1 L_fin
    ds_read_b128 v[32:35], v165 offset:2560
    ds_read_b128 v[36:39], v165 offset:2816
    s_waitcnt lgkmcnt(0)
    v_pk_add_f32 v[32:33], v[32:33], v[36:37]
    v_pk_add_f32 v[34:35], v[34:35], v[38:39]
    s_nop 0
    v_permlane16_swap_b32 v32, v33
    v_permlane16_swap_b32 v34, v35
    v_add_f32 v32, v32, v33
    v_add_f32 v34, v34, v35
    s_nop 1
    v_permlane32_swap_b32 v32, v34
    v_add_f32 v32, v32, v34
    v_add_u32 v34, 0x10000, v32
    v_and_or_b32 v34, v34, s53, v169
    s_nop 1
    v_mov_b32 v35, v34 row_shl:4 row_mask:0xf bank_mask:0xf
    v_perm_b32 v36, v35, v34, s57
    v_perm_b32 v38, v35, v34, s57
    s_nop 0
    v_mov_b32 v37, v36 row_shl:8 row_mask:0xf bank_mask:0xf
    v_mov_b32 v39, v36 row_shl:8 row_mask:0xf bank_mask:0xf
    v_permlane32_swap_b32 v36, v38
    s_nop 0
    v_permlane32_swap_b32 v37, v39
    s_mov_b64 exec, 0x000f000f
    global_store_dwordx4 v168, v[36:39], s[28:29] sc1
    s_mov_b64 exec, -1
    v_bfi_b32 v32, s61, v167, v32
    s_mov_b32 s62, 0x11111111
    s_mov_b32 s63, 0x11111111
    v_mov_b32 v33, v32 quad_perm:[1,1,1,1] row_mask:0xf bank_mask:0xf
    v_mov_b32 v34, v32 quad_perm:[2,2,2,2] row_mask:0xf bank_mask:0xf
    v_mov_b32 v35, v32 quad_perm:[3,3,3,3] row_mask:0xf bank_mask:0xf
    s_mov_b64 exec, s[62:63]
    global_store_dwordx4 v166, v[32:35], s[28:29] sc1
    s_branch L_fin
L_att_ffn:
    s_min_u32 s35, s32, 3
    s_mul_i32 s39, s32, 5
    s_add_u32 s39, s39, s35
    s_add_u32 s39, s39, s33
    s_sub_u32 s39, s39, 16
    s_mul_i32 s35, s38, 352256
    s_lshl_b32 s37, s39, 6
    s_add_u32 s35, s35, s37
    s_add_u32 s16, s16, s35
    s_addc_u32 s17, s17, 0
    s_lshl_b32 s35, s39, 15
    s_lshl_b32 s37, s38, 8
    s_add_u32 s35, s35, s37
    s_add_u32 s20, s20, s35
    s_addc_u32 s21, s21, 0
    v_lshrrev_b32 v8, 2, v2
    v_lshl_add_u32 v18, v8, 3, v1
    v_mul_u32_u24 v8, 2752, v18
    v_and_b32 v9, 3, v0
    v_lshl_add_u32 v16, v9, 4, v8
    v_lshrrev_b32 v8, 3, v2
    v_lshl_add_u32 v8, v1, 1, v8
    v_lshlrev_b32 v8, 12, v8
    v_and_b32 v9, 7, v0
    v_lshl_add_u32 v17, v9, 4, v8
    v_lshl_add_u32 v19, v1, 3, v9
    s_lshl_b32 s35, s39, 6
    v_lshl_add_u32 v19, v19, 1, s35
    v_and_b32 v8, 1, v0
    v_lshl_add_u32 v18, v8, 2, v18
    v_bfe_u32 v8, v0, 1, 1
    v_lshl_add_u32 v18, v8, 5, v18
    s_lshl_b32 s35, s38, 8
    v_lshl_add_u32 v18, v18, 1, s35
    v_mov_b32 v20, 0
    v_mov_b32 v21, 0
    v_mov_b32 v22, 0
    global_load_dwordx4 v[80:83], v10, s[8:9] offset:0 nt
    global_load_dwordx4 v[84:87], v10, s[8:9] offset:1024 nt
    global_load_dwordx4 v[88:91], v10, s[8:9] offset:2048 nt
    global_load_dwordx4 v[92:95], v10, s[8:9] offset:3072 nt
    s_barrier
    s_mov_b64 exec, s[46:47]
    ds_read_b128 v[160:163], v12 offset:0
    s_mov_b64 exec, s[48:49]
    ds_read_b128 v[164:167], v12 offset:0
    s_mov_b64 exec, s[50:51]
    ds_read_b128 v[168:171], v12 offset:0
    s_mov_b64 exec, s[52:53]
    ds_read_b128 v[172:175], v12 offset:0
    s_mov_b64 exec, -1
    s_waitcnt vmcnt(8) lgkmcnt(0)
    v_mfma_f32_16x16x32_bf16 v[176:179], v[32:35], v[160:163], 0
    v_mfma_f32_16x16x32_bf16 v[180:183], v[48:51], v[160:163], 0
    v_mfma_f32_16x16x32_bf16 v[176:179], v[36:39], v[164:167], v[176:179]
    v_mfma_f32_16x16x32_bf16 v[180:183], v[52:55], v[164:167], v[180:183]
    v_mfma_f32_16x16x32_bf16 v[176:179], v[40:43], v[168:171], v[176:179]
    v_mfma_f32_16x16x32_bf16 v[180:183], v[56:59], v[168:171], v[180:183]
    v_mfma_f32_16x16x32_bf16 v[176:179], v[44:47], v[172:175], v[176:179]
    v_mfma_f32_16x16x32_bf16 v[180:183], v[60:63], v[172:175], v[180:183]
    s_add_u32 s34, s34, 1
    s_nop 5
    v_mov_b32 v24, v176 quad_perm:[0,0,0,0] row_mask:0xf bank_mask:0xf
    v_mov_b32 v25, v180 quad_perm:[0,0,0,0] row_mask:0xf bank_mask:0xf
    s_nop 0
    v_add_f32 v24, v177, v24 quad_perm:[1,1,1,1] row_mask:0xf bank_mask:0xf
    v_add_f32 v25, v181, v25 quad_perm:[1,1,1,1] row_mask:0xf bank_mask:0xf
    s_nop 0
    v_add_f32 v24, v178, v24 quad_perm:[2,2,2,2] row_mask:0xf bank_mask:0xf
    v_add_f32 v25, v182, v25 quad_perm:[2,2,2,2] row_mask:0xf bank_mask:0xf
    s_nop 0
    v_add_f32 v24, v179, v24 quad_perm:[3,3,3,3] row_mask:0xf bank_mask:0xf
    v_add_f32 v25, v183, v25 quad_perm:[3,3,3,3] row_mask:0xf bank_mask:0xf
    v_cvt_pk_bf16_f32 v24, v24, v25
    v_and_b32 v25, s42, v24
    v_lshlrev_b32 v24, 16, v24
    v_mul_f32 v24, 0x3db504f3, v24
    v_mul_f32 v25, 0x3db504f3, v25
    v_cvt_pk_bf16_f32 v24, v24, v25
    v_and_b32 v25, s42, v24
    v_lshlrev_b32 v24, 16, v24
    v_max_f32 v26, v24, v25
    s_nop 1
    v_max_f32 v26, v26, v26 row_ror:4 row_mask:0xf bank_mask:0xf
    s_nop 1
    v_max_f32 v26, v26, v26 row_ror:8 row_mask:0xf bank_mask:0xf
    v_mov_b32 v27, v26
    s_nop 1
    v_permlane16_swap_b32 v26, v27
    v_max_f32 v26, v26, v27
    v_mov_b32 v27, v26
    s_nop 1
    v_permlane32_swap_b32 v26, v27
    v_max_f32 v26, v26, v27
    v_sub_f32 v28, v24, v26
    v_sub_f32 v29, v25, v26
    v_mul_f32 v28, s43, v28
    v_mul_f32 v29, s43, v29
    v_exp_f32 v28, v28
    v_exp_f32 v29, v29
    s_nop 0
    v_add_f32 v27, v28, v29
    s_nop 1
    v_add_f32 v27, v27, v27 row_ror:4 row_mask:0xf bank_mask:0xf
    s_nop 1
    v_add_f32 v27, v27, v27 row_ror:8 row_mask:0xf bank_mask:0xf
    v_mov_b32 v28, v27
    s_nop 1
    v_permlane16_swap_b32 v27, v28
    v_add_f32 v27, v27, v28
    v_mov_b32 v28, v27
    s_nop 1
    v_permlane32_swap_b32 v27, v28
    v_add_f32 v27, v27, v28
    s_mov_b64 exec, 1
    ds_write_b64 v13, v[26:27] offset:256
    s_mov_b64 exec, -1
    v_and_b32 v8, 3, v0
    v_lshlrev_b32 v8, 3, v8
    s_waitcnt lgkmcnt(0)
    s_barrier
    ds_read_b32 v26, v8 offset:256
    s_waitcnt lgkmcnt(0)
    v_max_f32 v26, v26, v26 quad_perm:[1,0,3,2] row_mask:0xf bank_mask:0xf
    s_nop 1
    v_max_f32 v26, v26, v26 quad_perm:[2,3,0,1] row_mask:0xf bank_mask:0xf
    v_sub_f32 v28, v24, v26
    v_sub_f32 v29, v25, v26
    v_mul_f32 v28, s43, v28
    v_mul_f32 v29, s43, v29
    v_exp_f32 v28, v28
    v_exp_f32 v29, v29
    v_cvt_pk_bf16_f32 v28, v28, v28
    v_cvt_pk_bf16_f32 v29, v29, v29
    s_nop 0
    v_and_b32 v32, v28, v4 row_newbcast:0 row_mask:0xf bank_mask:0xf
    v_and_b32 v33, v28, v5 row_newbcast:0 row_mask:0xf bank_mask:0xf
    v_and_b32 v34, v28, v6 row_newbcast:0 row_mask:0xf bank_mask:0xf
    v_and_b32 v35, v28, v7 row_newbcast:0 row_mask:0xf bank_mask:0xf
    v_and_b32 v36, v28, v4 row_newbcast:4 row_mask:0xf bank_mask:0xf
    v_and_b32 v37, v28, v5 row_newbcast:4 row_mask:0xf bank_mask:0xf
    v_and_b32 v38, v28, v6 row_newbcast:4 row_mask:0xf bank_mask:0xf
    v_and_b32 v39, v28, v7 row_newbcast:4 row_mask:0xf bank_mask:0xf
    v_and_b32 v40, v28, v4 row_newbcast:8 row_mask:0xf bank_mask:0xf
    v_and_b32 v41, v28, v5 row_newbcast:8 row_mask:0xf bank_mask:0xf
    v_and_b32 v42, v28, v6 row_newbcast:8 row_mask:0xf bank_mask:0xf
    v_and_b32 v43, v28, v7 row_newbcast:8 row_mask:0xf bank_mask:0xf
    v_and_b32 v44, v28, v4 row_newbcast:12 row_mask:0xf bank_mask:0xf
    v_and_b32 v45, v28, v5 row_newbcast:12 row_mask:0xf bank_mask:0xf
    v_and_b32 v46, v28, v6 row_newbcast:12 row_mask:0xf bank_mask:0xf
    v_and_b32 v47, v28, v7 row_newbcast:12 row_mask:0xf bank_mask:0xf
    v_and_b32 v48, v29, v4 row_newbcast:0 row_mask:0xf bank_mask:0xf
    v_and_b32 v49, v29, v5 row_newbcast:0 row_mask:0xf bank_mask:0xf
    v_and_b32 v50, v29, v6 row_newbcast:0 row_mask:0xf bank_mask:0xf
    v_and_b32 v51, v29, v7 row_newbcast:0 row_mask:0xf bank_mask:0xf
    v_and_b32 v52, v29, v4 row_newbcast:4 row_mask:0xf bank_mask:0xf
    v_and_b32 v53, v29, v5 row_newbcast:4 row_mask:0xf bank_mask:0xf
    v_and_b32 v54, v29, v6 row_newbcast:4 row_mask:0xf bank_mask:0xf
    v_and_b32 v55, v29, v7 row_newbcast:4 row_mask:0xf bank_mask:0xf
    v_and_b32 v56, v29, v4 row_newbcast:8 row_mask:0xf bank_mask:0xf
    v_and_b32 v57, v29, v5 row_newbcast:8 row_mask:0xf bank_mask:0xf
    v_and_b32 v58, v29, v6 row_newbcast:8 row_mask:0xf bank_mask:0xf
    v_and_b32 v59, v29, v7 row_newbcast:8 row_mask:0xf bank_mask:0xf
    v_and_b32 v60, v29, v4 row_newbcast:12 row_mask:0xf bank_mask:0xf
    v_and_b32 v61, v29, v5 row_newbcast:12 row_mask:0xf bank_mask:0xf
    v_and_b32 v62, v29, v6 row_newbcast:12 row_mask:0xf bank_mask:0xf
    v_and_b32 v63, v29, v7 row_newbcast:12 row_mask:0xf bank_mask:0xf
    s_lshl_b32 s35, s30, 12
    s_lshl_b32 s37, s31, 9
    s_add_u32 s35, s35, s37
    s_add_u32 s35, s35, 196608
    v_lshl_add_u32 v24, v0, 3, s35
    v_lshrrev_b32 v25, 1, v0
    v_add_u32 v25, s34, v25
    v_and_b32 v26, 31, v0
    v_lshrrev_b32 v27, 5, v0
    v_lshlrev_b32 v27, 10, v27
    v_lshl_add_u32 v26, v26, 4, v27
    s_lshl_b32 s35, s38, 13
    s_add_u32 s35, s35, 397312
    v_add_u32 v160, s35, v10
    v_add_u32 v8, s34, v2
    v_and_b32 v161, s61, v8
    s_lshl_b32 s35, s38, 9
    v_lshl_add_u32 v162, v0, 3, s35
    v_lshlrev_b32 v163, 5, v0
    v_or_b32 v164, v4, v6
    v_or_b32 v165, v5, v7
    v_lshl_add_u32 v8, v1, 7, s35
    v_and_b32 v9, 3, v0
    v_lshl_add_u32 v166, v9, 4, v8
    s_mul_i32 s35, s38, 24576
    s_lshl_b32 s37, s39, 7
    s_add_u32 s35, s35, s37
    s_add_u32 s35, s35, 458752
    v_mul_u32_u24 v8, 6144, v1
    v_lshl_add_u32 v8, v3, 4, v8
    v_add_u32 v167, s35, v8
    v_add_u32 v168, s34, v3
    v_mov_b32 v169, 0
    s_mov_b32 s58, 0x00f0000f
    s_mov_b32 s59, 0xf0000f00
    s_lshl_b32 s35, s38, 12
    s_add_u32 s35, s35, 425984
    v_add_u32 v160, s35, v10
    v_and_b32 v8, 7, v0
    v_add_u32 v8, s34, v8
    v_and_b32 v8, s61, v8
    v_lshl_or_b32 v8, v8, 15, v8
    v_lshrrev_b32 v9, 0, v8
    v_and_b32 v161, 0x10001, v9
    v_lshrrev_b32 v9, 2, v8
    v_and_b32 v163, 0x10001, v9
    v_lshrrev_b32 v9, 4, v8
    v_and_b32 v170, 0x10001, v9
    v_lshrrev_b32 v9, 6, v8
    v_and_b32 v171, 0x10001, v9
    v_and_b32 v172, 0x3f803f80, v4
    v_and_b32 v173, 0x3f803f80, v5
    v_and_b32 v174, 0x3f803f80, v6
    v_and_b32 v175, 0x3f803f80, v7
    s_load_dword s54, s[4:5], 0
    s_mov_b64 s[48:49], -1
    v_lshrrev_b32 v8, 5, v0
    s_lshl_b32 s35, s38, 3
    v_lshl_add_u32 v162, v8, 2, s35
    s_waitcnt vmcnt(7)
    v_mfma_f32_16x16x32_bf16 v[184:187], v[64:67], v[32:35], 0
    s_waitcnt vmcnt(6)
    v_mfma_f32_16x16x32_bf16 v[184:187], v[68:71], v[36:39], v[184:187]
    s_waitcnt vmcnt(5)
    v_mfma_f32_16x16x32_bf16 v[184:187], v[72:75], v[40:43], v[184:187]
    s_waitcnt vmcnt(4)
    v_mfma_f32_16x16x32_bf16 v[184:187], v[76:79], v[44:47], v[184:187]
    s_waitcnt vmcnt(3)
    v_mfma_f32_16x16x32_bf16 v[184:187], v[80:83], v[48:51], v[184:187]
    s_waitcnt vmcnt(2)
    v_mfma_f32_16x16x32_bf16 v[184:187], v[84:87], v[52:55], v[184:187]
    s_waitcnt vmcnt(1)
    v_mfma_f32_16x16x32_bf16 v[184:187], v[88:91], v[56:59], v[184:187]
    s_waitcnt vmcnt(0)
    v_mfma_f32_16x16x32_bf16 v[184:187], v[92:95], v[60:63], v[184:187]
    s_mov_b64 exec, s[40:41]
    s_cmp_lg_u32 s38, 0
    s_nop 5
    ds_write_b128 v14, v[184:187] offset:512
    s_mov_b64 exec, -1
    s_waitcnt lgkmcnt(0)
    s_barrier
    s_cbranch_scc1 L_nopub_ffn
    ds_read_b128 v[32:35], v26 offset:512
    ds_read_b128 v[36:39], v26 offset:1024
    s_waitcnt lgkmcnt(0)
    v_pk_add_f32 v[32:33], v[32:33], v[36:37]
    v_pk_add_f32 v[34:35], v[34:35], v[38:39]
    s_nop 1
    v_permlane32_swap_b32 v32, v34
    v_permlane32_swap_b32 v33, v35
    v_pk_add_f32 v[32:33], v[32:33], v[34:35]
    v_bfi_b32 v28, s61, v25, v32
    v_bfi_b32 v29, s61, v25, v33
    s_nop 0
    v_mov_b32 v30, v28 quad_perm:[1,1,3,3] row_mask:0xf bank_mask:0xf
    v_mov_b32 v31, v29 quad_perm:[1,1,3,3] row_mask:0xf bank_mask:0xf
    s_mov_b64 exec, s[62:63]
    global_store_dwordx4 v24, v[28:31], s[28:29]
    v_add_u32 v24, 524288, v24
    global_store_dwordx4 v24, v[28:31], s[28:29] sc1
    s_mov_b64 exec, -1
L_nopub_ffn:
    s_barrier
    v_add_u32 v23, 0, v16
    global_load_dwordx4 v[96:99], v23, s[16:17]
    v_add_u32 v23, 11008, v16
    global_load_dwordx4 v[100:103], v23, s[16:17]
    v_add_u32 v23, 88064, v16
    global_load_dwordx4 v[104:107], v23, s[16:17]
    v_add_u32 v23, 99072, v16
    global_load_dwordx4 v[108:111], v23, s[16:17]
    v_add_u32 v23, 176128, v16
    global_load_dwordx4 v[112:115], v23, s[16:17]
    v_add_u32 v23, 187136, v16
    global_load_dwordx4 v[116:119], v23, s[16:17]
    v_add_u32 v23, 264192, v16
    global_load_dwordx4 v[120:123], v23, s[16:17]
    v_add_u32 v23, 275200, v16
    global_load_dwordx4 v[124:127], v23, s[16:17]
    global_load_short_d16_hi v20, v18, s[4:5]
    global_load_short_d16_hi v21, v18, s[4:5] offset:128
    global_load_short_d16_hi v22, v19, s[18:19]
    global_load_dwordx4 v[128:131], v17, s[20:21] offset:0
    global_load_dwordx4 v[132:135], v17, s[20:21] offset:1024
    global_load_dwordx4 v[136:139], v17, s[20:21] offset:2048
    global_load_dwordx4 v[140:143], v17, s[20:21] offset:3072
    global_load_dwordx4 v[144:147], v17, s[20:21] offset:128
    global_load_dwordx4 v[148:151], v17, s[20:21] offset:1152
    global_load_dwordx4 v[152:155], v17, s[20:21] offset:2176
    global_load_dwordx4 v[156:159], v17, s[20:21] offset:3200
    s_waitcnt vmcnt(11)
    v_swap_b32 v98, v100
    v_swap_b32 v99, v101
    v_swap_b32 v106, v108
    v_swap_b32 v107, v109
    v_swap_b32 v114, v116
    v_swap_b32 v115, v117
    v_swap_b32 v122, v124
    v_swap_b32 v123, v125
    v_and_b32 v64, 0x3f803f80, v164
    v_and_b32 v65, 0x3f803f80, v165
    v_and_b32 v66, 0x3f803f80, v164
    v_and_b32 v67, 0x3f803f80, v165
    s_nop 1
    v_mfma_f32_16x16x32_bf16 v[176:179], v[96:99], v[64:67], 0
    v_mfma_f32_16x16x32_bf16 v[180:183], v[100:103], v[64:67], 0
    v_mfma_f32_16x16x32_bf16 v[176:179], v[104:107], v[64:67], v[176:179]
    v_mfma_f32_16x16x32_bf16 v[180:183], v[108:111], v[64:67], v[180:183]
    v_mfma_f32_16x16x32_bf16 v[176:179], v[112:115], v[64:67], v[176:179]
    v_mfma_f32_16x16x32_bf16 v[180:183], v[116:119], v[64:67], v[180:183]
    v_mfma_f32_16x16x32_bf16 v[176:179], v[120:123], v[64:67], v[176:179]
    v_mfma_f32_16x16x32_bf16 v[180:183], v[124:127], v[64:67], v[180:183]
    s_mov_b64 exec, s[58:59]
    s_nop 5
    ds_write_b128 v166, v[176:179] offset:4608
    ds_write_b128 v166, v[180:183] offset:4672
    s_mov_b64 exec, -1
    s_waitcnt lgkmcnt(0)
    s_barrier
    ds_read_b128 v[68:71], v10 offset:4608
    ds_read_b128 v[72:75], v10 offset:5632
    s_lshl_b32 s54, s54, 16
    s_waitcnt lgkmcnt(0)
    v_pk_add_f32 v[68:69], v[68:69], v[72:73]
    v_pk_add_f32 v[70:71], v[70:71], v[74:75]
    s_nop 0
    v_permlane16_swap_b32 v68, v69
    v_permlane16_swap_b32 v70, v71
    v_add_f32 v68, v68, v69
    v_add_f32 v70, v70, v71
    s_nop 1
    v_permlane32_swap_b32 v68, v70
    v_add_f32 v68, v68, v70
    s_nop 1
    v_add_f32 v23, v68, v68 row_ror:8 row_mask:0xf bank_mask:0xf
    s_waitcnt vmcnt(0)
    s_mov_b32 s36, 200000
L_y2:
    global_load_dwordx4 v[32:35], v160, s[28:29] offset:0 sc1
    global_load_dwordx4 v[36:39], v160, s[28:29] offset:1024 sc1
    global_load_dwordx4 v[40:43], v160, s[28:29] offset:2048 sc1
    global_load_dwordx4 v[44:47], v160, s[28:29] offset:3072 sc1
    s_waitcnt vmcnt(0)
    v_xor_b32 v32, v32, v161
    v_xor_b32 v33, v33, v163
    v_xor_b32 v34, v34, v170
    v_xor_b32 v35, v35, v171
    v_xor_b32 v36, v36, v161
    v_xor_b32 v37, v37, v163
    v_xor_b32 v38, v38, v170
    v_xor_b32 v39, v39, v171
    v_xor_b32 v40, v40, v161
    v_xor_b32 v41, v41, v163
    v_xor_b32 v42, v42, v170
    v_xor_b32 v43, v43, v171
    v_xor_b32 v44, v44, v161
    v_xor_b32 v45, v45, v163
    v_xor_b32 v46, v46, v170
    v_xor_b32 v47, v47, v171
    v_or3_b32 v8, v32, v33, v34
    v_or3_b32 v8, v8, v35, v36
    v_or3_b32 v8, v8, v37, v38
    v_or3_b32 v8, v8, v39, v40
    v_or3_b32 v8, v8, v41, v42
    v_or3_b32 v8, v8, v43, v44
    v_or3_b32 v8, v8, v45, v46
    v_or_b32 v8, v8, v47
    v_and_b32 v8, 0x10001, v8
    v_cmp_ne_u32 vcc, 0, v8
    s_cbranch_vccnz L_y2_r
L_y2_d:
L_ftail:
    v_mfma_f32_16x16x32_bf16 v[48:51], v[32:35], v[172:175], 0
    v_mfma_f32_16x16x32_bf16 v[52:55], v[40:43], v[172:175], 0
    v_mfma_f32_16x16x32_bf16 v[48:51], v[36:39], v[172:175], v[48:51]
    v_mfma_f32_16x16x32_bf16 v[52:55], v[44:47], v[172:175], v[52:55]
    s_nop 6
    v_permlane32_swap_b32 v48, v49
    v_permlane32_swap_b32 v50, v51
    v_permlane32_swap_b32 v52, v53
    v_permlane32_swap_b32 v54, v55
    v_add_f32 v48, v48, v49
    v_add_f32 v52, v52, v53
    s_nop 0
    v_add_f32 v48, v50, v51 quad_perm:[0,1,2,3] row_mask:0xf bank_mask:0xa
    v_add_f32 v52, v54, v55 quad_perm:[0,1,2,3] row_mask:0xf bank_mask:0xa
    v_cvt_pk_bf16_f32 v32, v48, v52
    v_and_b32 v33, s42, v32
    v_lshlrev_b32 v32, 16, v32
    v_pk_add_f32 v[20:21], v[20:21], v[32:33]
    v_cvt_pk_bf16_f32 v20, v20, v20
    v_cvt_pk_bf16_f32 v21, v21, v21
    s_nop 0
    v_and_b32 v64, v20, v164 quad_perm:[0,0,0,0] row_mask:0xf bank_mask:0xf
    v_and_b32 v65, v20, v165 quad_perm:[0,0,0,0] row_mask:0xf bank_mask:0xf
    v_and_b32 v66, v20, v164 quad_perm:[1,1,1,1] row_mask:0xf bank_mask:0xf
    v_and_b32 v67, v20, v165 quad_perm:[1,1,1,1] row_mask:0xf bank_mask:0xf
    v_and_b32 v40, s42, v20
    v_and_b32 v41, s42, v21
    v_and_b32 v68, v20, v164 quad_perm:[2,2,2,2] row_mask:0xf bank_mask:0xf
    v_and_b32 v69, v20, v165 quad_perm:[2,2,2,2] row_mask:0xf bank_mask:0xf
    v_and_b32 v70, v20, v164 quad_perm:[3,3,3,3] row_mask:0xf bank_mask:0xf
    v_and_b32 v71, v20, v165 quad_perm:[3,3,3,3] row_mask:0xf bank_mask:0xf
    v_subrev_f32 v40, s54, v40
    v_subrev_f32 v41, s54, v41
    v_add_f32 v42, v40, v41
    v_mul_f32 v44, v40, v40
    v_fmac_f32 v44, v41, v41
    v_mfma_f32_16x16x32_bf16 v[176:179], v[96:99], v[64:67], 0
    v_mfma_f32_16x16x32_bf16 v[180:183], v[100:103], v[64:67], 0
    v_and_b32 v72, v21, v164 quad_perm:[0,0,0,0] row_mask:0xf bank_mask:0xf
    v_permlane32_swap_b32 v42, v44
    v_and_b32 v73, v21, v165 quad_perm:[0,0,0,0] row_mask:0xf bank_mask:0xf
    v_add_f32 v42, v42, v44
    v_and_b32 v74, v21, v164 quad_perm:[1,1,1,1] row_mask:0xf bank_mask:0xf
    v_and_b32 v75, v21, v165 quad_perm:[1,1,1,1] row_mask:0xf bank_mask:0xf
    v_add_f32 v42, v42, v42 row_ror:8 row_mask:0xf bank_mask:0xf
    v_mfma_f32_16x16x32_bf16 v[176:179], v[104:107], v[68:71], v[176:179]
    v_mfma_f32_16x16x32_bf16 v[180:183], v[108:111], v[68:71], v[180:183]
    v_and_b32 v76, v21, v164 quad_perm:[2,2,2,2] row_mask:0xf bank_mask:0xf
    v_and_b32 v77, v21, v165 quad_perm:[2,2,2,2] row_mask:0xf bank_mask:0xf
    v_add_f32 v42, v42, v42 row_ror:4 row_mask:0xf bank_mask:0xf
    v_and_b32 v78, v21, v164 quad_perm:[3,3,3,3] row_mask:0xf bank_mask:0xf
    v_and_b32 v79, v21, v165 quad_perm:[3,3,3,3] row_mask:0xf bank_mask:0xf
    v_add_f32 v42, v42, v42 row_ror:2 row_mask:0xf bank_mask:0xf
    v_mfma_f32_16x16x32_bf16 v[176:179], v[112:115], v[72:75], v[176:179]
    v_mfma_f32_16x16x32_bf16 v[180:183], v[116:119], v[72:75], v[180:183]
    v_mfma_f32_16x16x32_bf16 v[176:179], v[120:123], v[76:79], v[176:179]
    v_mfma_f32_16x16x32_bf16 v[180:183], v[124:127], v[76:79], v[180:183]
    v_add_f32 v42, v42, v42 row_ror:1 row_mask:0xf bank_mask:0xf
    v_mov_b32 v43, v42
    s_nop 1
    v_permlane16_swap_b32 v42, v43
    v_add_f32 v42, v42, v43
    s_mov_b64 exec, s[58:59]
    ds_write_b32 v162, v42 offset:256
    ds_write_b128 v166, v[176:179] offset:6656
    ds_write_b128 v166, v[180:183] offset:6720
    s_mov_b64 exec, s[48:49]
    s_cbranch_execz L_fnb
    s_waitcnt lgkmcnt(0)
    s_barrier
L_fnb:
    ds_read_b128 v[40:43], v169 offset:256
    ds_read_b128 v[44:47], v169 offset:272
    ds_read_b128 v[32:35], v10 offset:6656
    ds_read_b128 v[36:39], v10 offset:7680
    s_waitcnt lgkmcnt(2)
    v_pk_add_f32 v[40:41], v[40:41], v[42:43]
    v_pk_add_f32 v[44:45], v[44:45], v[46:47]
    v_pk_add_f32 v[40:41], v[40:41], v[44:45]
    v_mul_f32 v40, 0x3b000000, v40
    v_mul_f32 v41, 0x3b000000, v41
    v_fma_f32 v41, -v40, v40, v41
    v_add_f32 v40, s54, v40
    v_max_f32 v41, 0, v41
    v_cvt_pk_bf16_f32 v40, v40, v41
    v_and_b32 v41, s42, v40
    v_add_f32 v41, 0x3727c5ac, v41
    v_cvt_pk_bf16_f32 v41, v41, v41
    v_and_b32 v41, s42, v41
    v_sqrt_f32 v41, v41
    s_waitcnt lgkmcnt(0)
    v_pk_add_f32 v[32:33], v[32:33], v[36:37]
    v_pk_add_f32 v[34:35], v[34:35], v[38:39]
    v_cvt_pk_bf16_f32 v41, v41, v41
    v_lshlrev_b32 v40, 16, v40
    v_permlane16_swap_b32 v32, v33
    v_permlane16_swap_b32 v34, v35
    v_and_b32 v41, s42, v41
    v_add_f32 v32, v32, v33
    v_add_f32 v34, v34, v35
    v_rcp_f32 v41, v41
    v_mul_f32 v40, v40, v23
    v_permlane32_swap_b32 v32, v34
    v_add_f32 v32, v32, v34
    s_nop 1
    v_add_f32 v32, v32, v32 row_ror:8 row_mask:0xf bank_mask:0xf
    v_sub_f32 v32, v32, v40
    v_mul_f32 v32, v32, v41
    v_cvt_pk_bf16_f32 v32, v32, v32
    v_lshlrev_b32 v32, 16, v32
    v_add_f32 v32, v32, v22
    v_cvt_pk_bf16_f32 v32, v32, v32
    v_lshlrev_b32 v32, 16, v32
    v_max_f32 v32, 0, v32
    v_mul_f32 v32, v32, v32
    v_cvt_pk_bf16_f32 v32, v32, v32
    s_nop 1
    v_and_b32 v64, v32, v4 quad_perm:[0,0,0,0] row_mask:0xf bank_mask:0xf
    v_and_b32 v65, v32, v5 quad_perm:[0,0,0,0] row_mask:0xf bank_mask:0xf
    v_and_b32 v66, v32, v6 quad_perm:[0,0,0,0] row_mask:0xf bank_mask:0xf
    v_and_b32 v67, v32, v7 quad_perm:[0,0,0,0] row_mask:0xf bank_mask:0xf
    v_and_b32 v68, v32, v4 quad_perm:[1,1,1,1] row_mask:0xf bank_mask:0xf
    v_and_b32 v69, v32, v5 quad_perm:[1,1,1,1] row_mask:0xf bank_mask:0xf
    v_and_b32 v70, v32, v6 quad_perm:[1,1,1,1] row_mask:0xf bank_mask:0xf
    v_and_b32 v71, v32, v7 quad_perm:[1,1,1,1] row_mask:0xf bank_mask:0xf
    v_mfma_f32_16x16x32_bf16 v[176:179], v[128:131], v[64:67], 0
    v_mfma_f32_16x16x32_bf16 v[180:183], v[144:147], v[64:67], 0
    v_and_b32 v72, v32, v4 quad_perm:[2,2,2,2] row_mask:0xf bank_mask:0xf
    v_and_b32 v73, v32, v5 quad_perm:[2,2,2,2] row_mask:0xf bank_mask:0xf
    v_and_b32 v74, v32, v6 quad_perm:[2,2,2,2] row_mask:0xf bank_mask:0xf
    v_and_b32 v75, v32, v7 quad_perm:[2,2,2,2] row_mask:0xf bank_mask:0xf
    v_mfma_f32_16x16x32_bf16 v[176:179], v[132:135], v[68:71], v[176:179]
    v_mfma_f32_16x16x32_bf16 v[180:183], v[148:151], v[68:71], v[180:183]
    v_and_b32 v76, v32, v4 quad_perm:[3,3,3,3] row_mask:0xf bank_mask:0xf
    v_and_b32 v77, v32, v5 quad_perm:[3,3,3,3] row_mask:0xf bank_mask:0xf
    v_and_b32 v78, v32, v6 quad_perm:[3,3,3,3] row_mask:0xf bank_mask:0xf
    v_and_b32 v79, v32, v7 quad_perm:[3,3,3,3] row_mask:0xf bank_mask:0xf
    v_mfma_f32_16x16x32_bf16 v[176:179], v[136:139], v[72:75], v[176:179]
    v_mfma_f32_16x16x32_bf16 v[180:183], v[152:155], v[72:75], v[180:183]
    v_mfma_f32_16x16x32_bf16 v[176:179], v[140:143], v[76:79], v[176:179]
    v_mfma_f32_16x16x32_bf16 v[180:183], v[156:159], v[76:79], v[180:183]
    s_nop 7
    v_permlane32_swap_b32 v176, v180
    v_permlane32_swap_b32 v177, v181
    v_permlane32_swap_b32 v178, v182
    v_permlane32_swap_b32 v179, v183
    v_add_f32 v176, v180, v176 row_shl:4 row_mask:0xf bank_mask:0xf
    v_add_f32 v177, v181, v177 row_shl:4 row_mask:0xf bank_mask:0xf
    v_add_f32 v178, v182, v178 row_shl:4 row_mask:0xf bank_mask:0xf
    v_add_f32 v179, v183, v179 row_shl:4 row_mask:0xf bank_mask:0xf
    v_bfi_b32 v176, s61, v168, v176
    v_bfi_b32 v177, s61, v168, v177
    v_bfi_b32 v178, s61, v168, v178
    v_bfi_b32 v179, s61, v168, v179
    s_mov_b64 exec, s[40:41]
    global_store_dwordx4 v167, v[176:179], s[28:29] sc1
L_fin:
L_end:
    s_endpgm
L_qs:
    s_mov_b64 exec, s[40:41]
    global_store_dwordx4 v31, v[160:163], s[44:45] sc1
    s_mov_b64 exec, -1
    s_waitcnt vmcnt(0)
    global_load_dwordx4 v[48:51], v10, s[44:45] offset:0 sc1
    global_load_dwordx4 v[52:55], v10, s[44:45] offset:1024 sc1
    global_load_dwordx4 v[56:59], v10, s[44:45] offset:2048 sc1
    global_load_dwordx4 v[60:63], v10, s[44:45] offset:3072 sc1
    global_load_dwordx4 v[64:67], v10, s[44:45] offset:0 sc1
    global_load_dwordx4 v[68:71], v10, s[44:45] offset:1024 sc1
    global_load_dwordx4 v[72:75], v10, s[44:45] offset:2048 sc1
    global_load_dwordx4 v[76:79], v10, s[44:45] offset:3072 sc1
    global_load_dwordx4 v[80:83], v10, s[44:45] offset:0 sc1
    global_load_dwordx4 v[84:87], v10, s[44:45] offset:1024 sc1
    global_load_dwordx4 v[88:91], v10, s[44:45] offset:2048 sc1
    global_load_dwordx4 v[92:95], v10, s[44:45] offset:3072 sc1
    s_branch L_qs_d
L_rdry:
    s_add_u32 s35, s35, 1
    s_cmp_eq_u32 s38, s35
    s_cbranch_scc0 L_fin
    v_mov_b32 v16, 0
    s_mov_b64 s[46:47], 0
    s_mov_b32 s39, 1
    s_mov_b64 exec, 0
    s_branch L_rp_b
L_rh1_r:
    s_sub_u32 s36, s36, 1
    s_cbranch_scc0 L_rh1
    s_branch L_rh1_d
L_rp_x:
    s_waitcnt vmcnt(0)
    s_branch L_rp_a
L_rp_b:
    v_pk_add_f32 v[32:33], v[64:65], v[68:69]
    v_pk_add_f32 v[34:35], v[66:67], v[70:71]
    v_pk_add_f32 v[32:33], v[32:33], v[72:73]
    v_pk_add_f32 v[34:35], v[34:35], v[74:75]
    s_branch L_rp_c
L_wq_x:
    s_waitcnt vmcnt(0)
    s_branch L_wp_r
L_wq_b:
    v_pk_mul_f32 v[32:33], v[56:57], v[40:41] op_sel_hi:[1,0]
    v_pk_mul_f32 v[34:35], v[58:59], v[40:41] op_sel_hi:[1,0]
    v_pk_mul_f32 v[36:37], v[60:61], v[40:41] op_sel_hi:[1,0]
    v_pk_mul_f32 v[38:39], v[62:63], v[40:41] op_sel_hi:[1,0]
    s_branch L_wq_c
L_wp_r:
    s_sub_u32 s36, s36, 1
    s_cbranch_scc1 L_wp_d
    s_and_b32 s35, s36, 7
    s_cmp_le_u32 s35, 1
    s_cselect_b32 s35, 524288, 0
    v_xor_b32 v160, s35, v160
    v_xor_b32 v161, s35, v161
    global_load_dwordx4 v[40:43], v160, s[28:29] sc1
    s_cbranch_scc0 L_wp
    s_mov_b64 exec, s[50:51]
    global_store_dwordx4 v24, v[28:31], s[28:29] sc1
    s_mov_b64 exec, -1
    s_branch L_wp
L_y2_r:
    s_sub_u32 s36, s36, 1
    s_cbranch_scc0 L_y2
    s_branch L_y2_d
L_codeend:
.section .rodata,"a"
.p2align 6
.amdhsa_kernel sequential_preLN__sliding_block_cached__dense_activation_squared_relu__decode_kernel
  .amdhsa_next_free_vgpr 192
  .amdhsa_next_free_sgpr 102
  .amdhsa_accum_offset 192
  .amdhsa_group_segment_fixed_size 0
  .amdhsa_kernarg_size 104
  .amdhsa_user_sgpr_count 2
  .amdhsa_user_sgpr_kernarg_segment_ptr 1
  .amdhsa_system_sgpr_workgroup_id_x 1
  .amdhsa_float_denorm_mode_32 3
.end_amdhsa_kernel
```
